```python
import torch

def _softmax(x, axis=-1):
    return torch.softmax(x, dim=axis)
def _gelu(x):
    return torch.nn.functional.gelu(x, approximate="tanh")
def _silu(x):
    return torch.nn.functional.silu(x)
def _sigmoid(x):
    return torch.sigmoid(x)
def _layernorm(x, axis=-1, eps=1e-5):
    m = x.mean(dim=axis, keepdim=True)
    v = x.var(dim=axis, keepdim=True, unbiased=False)
    return (x - m) / torch.sqrt(v + eps)
def _scatter_add(tgt, idx, src, axis=0):
    return tgt.clone().index_add_(axis, idx, src)
def _segment_sum(src, seg, n):
    out = torch.zeros((n,) + src.shape[1:], dtype=src.dtype)
    return out.index_add_(0, seg, src)
def _pad(x, pw):
    flat = tuple(v for pair in reversed(pw) for v in pair)
    return torch.nn.functional.pad(x, flat)

kernel_name = 'gated_mix__gqa_block_cached__swiglu_ffn__decode'

def setup_inputs():

    _w = (lambda a: (lambda t: t.to(torch.bfloat16) if t.is_floating_point() else t)(torch.as_tensor(a)))
    def _A_setup():
        B, Sq, D = 2, 1, 512
        Hq, Hkv, Sk, Dh = 32, 8, 8192, 128
        assert Hq % Hkv == 0, (Hq, Hkv)
        return {
            "x": _w((lambda *s: torch.randn(*s, dtype=torch.bfloat16) * 0.05)(B, Sq, D)),
            "k_cache": _w((lambda *s: torch.randn(*s, dtype=torch.bfloat16) * 6.4)(B, Hkv, Sk, Dh)),
            "v_cache": _w((lambda *s: torch.randn(*s, dtype=torch.bfloat16) * 0.2)(B, Hkv, Sk, Dh)),
            "wq": _w((lambda *s: torch.randn(*s, dtype=torch.bfloat16) * 6.4)(D, Hq * Dh) * (D ** -0.5)),
            "wo": _w((lambda *s: torch.randn(*s, dtype=torch.bfloat16) * 0.2)(Hq * Dh, D) * ((Hq * Dh) ** -0.5)),
        }
    _A_in = _A_setup()

    def _B_setup():
        B, S, D, F = 2, 1, 512, 1792
        return {
            "x": _w((lambda *s: torch.randn(*s, dtype=torch.bfloat16) * 0.05)(B, S, D)),
            "w_gate": _w((lambda *s: torch.randn(*s, dtype=torch.bfloat16) * 0.05)(D, F)),
            "w_up": _w((lambda *s: torch.randn(*s, dtype=torch.bfloat16) * 0.05)(D, F)),
            "w_down": _w((lambda *s: torch.randn(*s, dtype=torch.bfloat16) * 0.05)(F, D)),
        }
    _B_in = _B_setup()

    return {
        "A_x": _A_in["x"],
        "A_k_cache": _A_in["k_cache"],
        "A_v_cache": _A_in["v_cache"],
        "A_wq": _A_in["wq"],
        "A_wo": _A_in["wo"],
        "B_x": _B_in["x"],
        "B_w_gate": _B_in["w_gate"],
        "B_w_up": _B_in["w_up"],
        "B_w_down": _B_in["w_down"],
        "gate_w": _w((lambda *s: torch.randn(*s, dtype=torch.bfloat16) * 0.05)(512) * 16.0),
    }

def reference(A_x, A_k_cache, A_v_cache, A_wq, A_wo, B_x, B_w_gate, B_w_up, B_w_down, gate_w):
    def _A_ref(x, k_cache, v_cache, wq, wo):
        B, Sq, D = x.shape
        Hq, Dh = 32, 128
        Hkv = k_cache.shape[1]
        rep = Hq // Hkv
        q = (lambda x, *d: x.permute(*d))((x @ wq).reshape(B, Sq, Hq, Dh), 0, 2, 1, 3)
        k = (lambda x, n, axis: torch.repeat_interleave(x, n, dim=axis))(k_cache, rep, axis=1)
        v = (lambda x, n, axis: torch.repeat_interleave(x, n, dim=axis))(v_cache, rep, axis=1)
        scores = torch.einsum("bhqd,bhkd->bhqk", q, k) * (Dh ** -0.5)
        p = _softmax(scores, axis=-1)
        o = torch.einsum("bhqk,bhkd->bhqd", p, v)
        return (lambda x, *d: x.permute(*d))(o, 0, 2, 1, 3).reshape(B, Sq, Hq * Dh) @ wo

    def _B_ref(x, w_gate, w_up, w_down):
        g = _silu(x @ w_gate)
        u = x @ w_up
        return (g * u) @ w_down

    x = A_x
    g = _sigmoid((x * gate_w).sum(-1, keepdims=True))
    a = _A_ref(x, A_k_cache, A_v_cache, A_wq, A_wo)
    b = _B_ref(x, B_w_gate, B_w_up, B_w_down)
    return g * a + (1 - g) * b
```

```asm
; @launch grid=(256,1,1) block=(896,1,1) lds=163840
.amdgcn_target "amdgcn-amd-amdhsa--gfx950"
.text
.globl gated_mix__gqa_block_cached__swiglu_ffn__decode_kernel
.p2align 8
.type gated_mix__gqa_block_cached__swiglu_ffn__decode_kernel,@function
gated_mix__gqa_block_cached__swiglu_ffn__decode_kernel:
  s_cmp_ge_u32 s2, 256
  s_cbranch_scc1 L_exit
  v_lshrrev_b32 v1, 6, v0
  s_and_b32 s4, s2, 7
  s_lshr_b32 s5, s2, 3
  s_mov_b32 s48, 0
  v_readfirstlane_b32 s3, v1
  s_nop 0
  s_cmp_ge_u32 s3, 10
  s_cbranch_scc1 L_LD
  s_cmp_ge_u32 s3, 2
  s_cbranch_scc1 L_CW
  s_cmp_eq_u32 s3, 1
  s_cbranch_scc1 L_J1
L_J0:
  s_load_dwordx2 s[16:17], s[0:1], 24
  s_mov_b32 s18, 4194304
  s_mov_b32 s19, 0x20000
  s_load_dwordx2 s[20:21], s[0:1], 0
  s_mov_b32 s22, 2048
  s_mov_b32 s23, 0x20000
  s_load_dwordx2 s[24:25], s[0:1], 96
  s_mov_b32 s26, 4194304
  s_mov_b32 s27, 0x20000
  s_barrier
  v_and_b32 v1, 63, v0
  v_lshrrev_b32 v2, 4, v1
  v_and_b32 v3, 15, v1
  s_lshr_b32 s8, s5, 2
  s_and_b32 s9, s5, 3
  s_mul_i32 s10, s9, 128*8192
  s_lshl_b32 s6, s4, 10
  s_add_u32 s10, s10, s6
  s_lshl_b32 s6, s8, 7
  s_add_u32 s10, s10, s6
  s_getreg_b32 s12, hwreg(HW_REG_XCC_ID, 0, 4)
  v_mov_b32 v90, 161472
  v_mov_b32 v91, 1
  s_waitcnt lgkmcnt(0)
  v_lshrrev_b32 v4, 5, v1
  v_lshlrev_b32 v4, 3, v4
  v_bfe_u32 v5, v1, 3, 2
  v_add_u32 v4, v4, v5
  v_mul_u32_u24 v4, 8192, v4
  v_and_b32 v5, 7, v1
  v_bfe_u32 v6, v1, 4, 2
  v_lshlrev_b32 v6, 1, v6
  v_xor_b32 v5, v5, v6
  v_lshlrev_b32 v5, 4, v5
  v_add_u32 v4, v4, v5
  s_mov_b32 m0, 0
  s_add_u32 s7, s10, 0
  buffer_load_dwordx4 v4, s[16:19], s7 offen nt lds
  s_mov_b32 m0, 1024
  s_add_u32 s7, s10, 131072
  buffer_load_dwordx4 v4, s[16:19], s7 offen nt lds
  s_mov_b32 m0, 2048
  s_add_u32 s7, s10, 32768
  buffer_load_dwordx4 v4, s[16:19], s7 offen nt lds
  s_mov_b32 m0, 3072
  s_add_u32 s7, s10, 163840
  buffer_load_dwordx4 v4, s[16:19], s7 offen nt lds
  s_mov_b32 m0, 4096
  s_add_u32 s7, s10, 262144
  buffer_load_dwordx4 v4, s[16:19], s7 offen nt lds
  s_mov_b32 m0, 5120
  s_add_u32 s7, s10, 393216
  buffer_load_dwordx4 v4, s[16:19], s7 offen nt lds
  s_mov_b32 m0, 6144
  s_add_u32 s7, s10, 294912
  buffer_load_dwordx4 v4, s[16:19], s7 offen nt lds
  s_mov_b32 m0, 7168
  s_add_u32 s7, s10, 425984
  buffer_load_dwordx4 v4, s[16:19], s7 offen nt lds
  s_mov_b32 m0, 8192
  s_add_u32 s7, s10, 524288
  buffer_load_dwordx4 v4, s[16:19], s7 offen nt lds
  s_mov_b32 m0, 9216
  s_add_u32 s7, s10, 655360
  buffer_load_dwordx4 v4, s[16:19], s7 offen nt lds
  s_mov_b32 m0, 10240
  s_add_u32 s7, s10, 557056
  buffer_load_dwordx4 v4, s[16:19], s7 offen nt lds
  s_mov_b32 m0, 11264
  s_add_u32 s7, s10, 688128
  buffer_load_dwordx4 v4, s[16:19], s7 offen nt lds
  s_mov_b32 m0, 12288
  s_add_u32 s7, s10, 786432
  buffer_load_dwordx4 v4, s[16:19], s7 offen nt lds
  s_mov_b32 m0, 13312
  s_add_u32 s7, s10, 917504
  buffer_load_dwordx4 v4, s[16:19], s7 offen nt lds
  s_mov_b32 m0, 14336
  s_add_u32 s7, s10, 819200
  buffer_load_dwordx4 v4, s[16:19], s7 offen nt lds
  s_mov_b32 m0, 15360
  s_add_u32 s7, s10, 950272
  buffer_load_dwordx4 v4, s[16:19], s7 offen nt lds
  v_and_b32 v5, 1, v3
  v_lshlrev_b32 v5, 10, v5
  v_lshlrev_b32 v6, 4, v2
  v_add_u32 v5, v5, v6
  s_lshl_b32 s6, s9, 8
  v_add_u32 v5, s6, v5
  buffer_load_dwordx4 v[8:11], v5, s[20:23], 0 offen offset:0
  buffer_load_dwordx4 v[12:15], v5, s[20:23], 0 offen offset:64
  buffer_load_dwordx4 v[16:19], v5, s[20:23], 0 offen offset:128
  buffer_load_dwordx4 v[20:23], v5, s[20:23], 0 offen offset:192
  v_lshrrev_b32 v6, 2, v3
  v_and_b32 v7, 3, v3
  v_lshlrev_b32 v28, 2, v2
  v_add_u32 v28, v28, v6
  v_lshlrev_b32 v28, 7, v28
  v_lshlrev_b32 v7, 3, v7
  v_add_u32 v28, v28, v7
  v_add_u32 v28, 0, v28
  v_lshlrev_b32 v29, 1, v2
  v_lshrrev_b32 v6, 1, v6
  v_add_u32 v29, v29, v6
  v_and_b32 v29, 3, v29
  v_xor_b32 v6, 0, v29
  v_lshlrev_b32 v6, 5, v6
  v_add_u32 v24, v28, v6
  v_xor_b32 v6, 1, v29
  v_lshlrev_b32 v6, 5, v6
  v_add_u32 v25, v28, v6
  v_xor_b32 v6, 2, v29
  v_lshlrev_b32 v6, 5, v6
  v_add_u32 v26, v28, v6
  v_xor_b32 v6, 3, v29
  v_lshlrev_b32 v6, 5, v6
  v_add_u32 v27, v28, v6
  s_load_dword s52, s[24:25], 557056
  s_mov_b32 s53, 0x07060500
  s_mov_b32 s54, 0x07060501
  s_mov_b32 s55, 0x07060502
  s_mov_b32 s56, 0x07060503
  s_mov_b32 s57, 0x0c0c0400
  s_mov_b32 s58, 0x04000c0c
  s_mov_b32 s63, 0xffffff00
  v_and_b32 v81, 3, v1
  v_add_u32 v81, 0x07060500, v81
  s_lshl_b32 s13, s12, 8
  v_mov_b32 v82, s13
  s_waitcnt vmcnt(0)
  s_waitcnt lgkmcnt(0)
  s_add_u32 s52, s52, 1
  v_mov_b32 v80, s52
  ds_read_b64_tr_b16 v[32:33], v24 offset:0
  ds_read_b64_tr_b16 v[34:35], v24 offset:2048
  ds_read_b64_tr_b16 v[36:37], v25 offset:0
  ds_read_b64_tr_b16 v[38:39], v25 offset:2048
  ds_read_b64_tr_b16 v[40:41], v26 offset:0
  ds_read_b64_tr_b16 v[42:43], v26 offset:2048
  ds_read_b64_tr_b16 v[44:45], v27 offset:0
  ds_read_b64_tr_b16 v[46:47], v27 offset:2048
  s_waitcnt lgkmcnt(0)
  ds_read_b64_tr_b16 v[48:49], v24 offset:4096
  ds_read_b64_tr_b16 v[50:51], v24 offset:6144
  ds_read_b64_tr_b16 v[52:53], v25 offset:4096
  ds_read_b64_tr_b16 v[54:55], v25 offset:6144
  ds_read_b64_tr_b16 v[56:57], v26 offset:4096
  ds_read_b64_tr_b16 v[58:59], v26 offset:6144
  ds_read_b64_tr_b16 v[60:61], v27 offset:4096
  ds_read_b64_tr_b16 v[62:63], v27 offset:6144
  v_mfma_f32_16x16x32_bf16 v[64:67], v[8:11], v[32:35], 0
  v_mfma_f32_16x16x32_bf16 v[68:71], v[8:11], v[36:39], 0
  v_mfma_f32_16x16x32_bf16 v[72:75], v[8:11], v[40:43], 0
  v_mfma_f32_16x16x32_bf16 v[76:79], v[8:11], v[44:47], 0
  s_waitcnt lgkmcnt(0)
  ds_read_b64_tr_b16 v[32:33], v24 offset:8192
  ds_read_b64_tr_b16 v[34:35], v24 offset:10240
  ds_read_b64_tr_b16 v[36:37], v25 offset:8192
  ds_read_b64_tr_b16 v[38:39], v25 offset:10240
  ds_read_b64_tr_b16 v[40:41], v26 offset:8192
  ds_read_b64_tr_b16 v[42:43], v26 offset:10240
  ds_read_b64_tr_b16 v[44:45], v27 offset:8192
  ds_read_b64_tr_b16 v[46:47], v27 offset:10240
  v_mfma_f32_16x16x32_bf16 v[64:67], v[12:15], v[48:51], v[64:67]
  v_mfma_f32_16x16x32_bf16 v[68:71], v[12:15], v[52:55], v[68:71]
  v_mfma_f32_16x16x32_bf16 v[72:75], v[12:15], v[56:59], v[72:75]
  v_mfma_f32_16x16x32_bf16 v[76:79], v[12:15], v[60:63], v[76:79]
  s_waitcnt lgkmcnt(0)
  ds_read_b64_tr_b16 v[48:49], v24 offset:12288
  ds_read_b64_tr_b16 v[50:51], v24 offset:14336
  ds_read_b64_tr_b16 v[52:53], v25 offset:12288
  ds_read_b64_tr_b16 v[54:55], v25 offset:14336
  ds_read_b64_tr_b16 v[56:57], v26 offset:12288
  ds_read_b64_tr_b16 v[58:59], v26 offset:14336
  ds_read_b64_tr_b16 v[60:61], v27 offset:12288
  ds_read_b64_tr_b16 v[62:63], v27 offset:14336
  v_mfma_f32_16x16x32_bf16 v[64:67], v[16:19], v[32:35], v[64:67]
  v_mfma_f32_16x16x32_bf16 v[68:71], v[16:19], v[36:39], v[68:71]
  v_mfma_f32_16x16x32_bf16 v[72:75], v[16:19], v[40:43], v[72:75]
  v_mfma_f32_16x16x32_bf16 v[76:79], v[16:19], v[44:47], v[76:79]
  s_waitcnt lgkmcnt(0)
  v_mfma_f32_16x16x32_bf16 v[64:67], v[20:23], v[48:51], v[64:67]
  v_mfma_f32_16x16x32_bf16 v[68:71], v[20:23], v[52:55], v[68:71]
  v_mfma_f32_16x16x32_bf16 v[72:75], v[20:23], v[56:59], v[72:75]
  v_mfma_f32_16x16x32_bf16 v[76:79], v[20:23], v[60:63], v[76:79]
  s_mov_b32 s40, 0xffff0000
  s_mov_b32 s41, 0
  s_mov_b32 s42, 0
  s_mov_b32 s43, 0x0000ffff
  s_mov_b32 s44, 0
  s_mov_b32 s45, 0xffff0000
  v_cndmask_b32 v40, v64, v68, s[40:41]
  v_cndmask_b32 v40, v40, v72, s[42:43]
  v_cndmask_b32 v40, v40, v76, s[44:45]
  v_cndmask_b32 v41, v65, v69, s[40:41]
  v_cndmask_b32 v41, v41, v73, s[42:43]
  v_cndmask_b32 v41, v41, v77, s[44:45]
  s_mov_b64 exec, 1
  ds_add_u32 v90, v91 offset:32
  s_mov_b64 exec, -1
  v_perm_b32 v40, v40, v80, v81
  v_perm_b32 v41, v41, v80, v81
  v_perm_b32 v82, v82, v80, v81
  s_lshl_b32 s6, s4, 3
  s_add_u32 s6, s6, s9
  s_lshl_b32 s6, s6, 11
  s_lshl_b32 s7, s8, 8
  s_add_u32 s6, s6, s7
  v_lshlrev_b32 v4, 2, v1
  v_add_u32 v5, s6, v4
  v_add_u32 v6, 8192, v5
  s_lshl_b32 s6, s4, 5
  s_add_u32 s6, s6, s5
  s_lshl_b32 s6, s6, 7
  s_add_u32 s6, s6, 196608
  v_add_u32 v7, s6, v4
  s_mov_b32 s14, 262144
  buffer_store_dword v40, v5, s[24:27], 0 offen
  buffer_store_dword v41, v6, s[24:27], 0 offen
  s_mov_b32 exec_hi, 0
  buffer_store_dword v82, v7, s[24:27], 0 offen
  s_mov_b32 exec_hi, -1
  buffer_store_dword v40, v5, s[24:27], s14 offen sc1
  buffer_store_dword v41, v6, s[24:27], s14 offen sc1
  s_mov_b32 exec_hi, 0
  buffer_store_dword v82, v7, s[24:27], s14 offen sc1
  s_mov_b32 exec_hi, -1
  s_lshl_b32 s6, s4, 1
  s_lshr_b32 s7, s5, 4
  s_add_u32 s6, s6, s7
  s_lshl_b32 s6, s6, 13
  v_lshlrev_b32 v4, 4, v1
  v_add_u32 v4, s6, v4
  v_and_b32 v5, 31, v1
  v_lshlrev_b32 v5, 7, v5
  s_lshl_b32 s6, s4, 12
  s_add_u32 s6, s6, 196608
  v_add_u32 v5, s6, v5
  s_mov_b32 s15, 0
  s_mov_b32 s11, 0
L_qg_1:
  s_add_u32 s7, s15, 0
  buffer_load_dwordx4 v[8:11], v4, s[24:27], s7 offen offset:0 sc1
  buffer_load_dwordx4 v[12:15], v4, s[24:27], s7 offen offset:1024 sc1
  s_add_u32 s7, s15, 2048
  buffer_load_dwordx4 v[16:19], v4, s[24:27], s7 offen offset:0 sc1
  buffer_load_dwordx4 v[20:23], v4, s[24:27], s7 offen offset:1024 sc1
  s_add_u32 s7, s15, 4096
  buffer_load_dwordx4 v[24:27], v4, s[24:27], s7 offen offset:0 sc1
  buffer_load_dwordx4 v[28:31], v4, s[24:27], s7 offen offset:1024 sc1
  s_add_u32 s7, s15, 6144
  buffer_load_dwordx4 v[32:35], v4, s[24:27], s7 offen offset:0 sc1
  buffer_load_dwordx4 v[36:39], v4, s[24:27], s7 offen offset:1024 sc1
  buffer_load_dwordx4 v[40:43], v5, s[24:27], s15 offen sc1
  s_add_u32 s48, s48, 1
  s_add_u32 s11, s11, 1
  s_waitcnt vmcnt(0)
  v_perm_b32 v46, v9, v8, s57
  v_perm_b32 v47, v11, v10, s58
  v_or_b32 v46, v46, v47
  v_xor_b32 v44, s52, v46
  v_perm_b32 v46, v13, v12, s57
  v_perm_b32 v47, v15, v14, s58
  v_or_b32 v46, v46, v47
  v_xor_b32 v45, s52, v46
  v_or_b32 v44, v44, v45
  v_perm_b32 v46, v17, v16, s57
  v_perm_b32 v47, v19, v18, s58
  v_or_b32 v46, v46, v47
  v_xor_b32 v45, s52, v46
  v_or_b32 v44, v44, v45
  v_perm_b32 v46, v21, v20, s57
  v_perm_b32 v47, v23, v22, s58
  v_or_b32 v46, v46, v47
  v_xor_b32 v45, s52, v46
  v_or_b32 v44, v44, v45
  v_perm_b32 v46, v25, v24, s57
  v_perm_b32 v47, v27, v26, s58
  v_or_b32 v46, v46, v47
  v_xor_b32 v45, s52, v46
  v_or_b32 v44, v44, v45
  v_perm_b32 v46, v29, v28, s57
  v_perm_b32 v47, v31, v30, s58
  v_or_b32 v46, v46, v47
  v_xor_b32 v45, s52, v46
  v_or_b32 v44, v44, v45
  v_perm_b32 v46, v33, v32, s57
  v_perm_b32 v47, v35, v34, s58
  v_or_b32 v46, v46, v47
  v_xor_b32 v45, s52, v46
  v_or_b32 v44, v44, v45
  v_perm_b32 v46, v37, v36, s57
  v_perm_b32 v47, v39, v38, s58
  v_or_b32 v46, v46, v47
  v_xor_b32 v45, s52, v46
  v_or_b32 v44, v44, v45
  v_perm_b32 v46, v41, v40, s57
  v_perm_b32 v47, v43, v42, s58
  v_or_b32 v46, v46, v47
  v_xor_b32 v45, s52, v46
  v_or_b32 v44, v44, v45
  v_cmp_ne_u32 vcc, 0, v44
  s_cbranch_vccz L_qgd_2
  s_cmp_gt_u32 s48, 300000
  s_cbranch_scc1 L_qgd_2
  s_sleep 2
  s_cmp_lt_u32 s11, 10
  s_cbranch_scc1 L_qg_1
  s_xor_b32 s15, s15, 262144
  s_branch L_qg_1
L_qgd_2:
  v_bfe_u32 v40, v40, 8, 4
  v_cmp_ne_u32 vcc, s12, v40
  s_nop 0
  s_cmp_eq_u64 vcc, 0
  s_cselect_b32 s6, 1, 0
  v_mov_b32 v44, s6
  s_mov_b64 exec, 1
  ds_write_b32 v90, v44 offset:24
  s_mov_b64 exec, -1
  v_and_b32 v8, s63, v8
  v_and_b32 v9, s63, v9
  v_and_b32 v10, s63, v10
  v_and_b32 v11, s63, v11
  v_and_b32 v12, s63, v12
  v_and_b32 v13, s63, v13
  v_and_b32 v14, s63, v14
  v_and_b32 v15, s63, v15
  v_and_b32 v16, s63, v16
  v_and_b32 v17, s63, v17
  v_and_b32 v18, s63, v18
  v_and_b32 v19, s63, v19
  v_and_b32 v20, s63, v20
  v_and_b32 v21, s63, v21
  v_and_b32 v22, s63, v22
  v_and_b32 v23, s63, v23
  v_and_b32 v24, s63, v24
  v_and_b32 v25, s63, v25
  v_and_b32 v26, s63, v26
  v_and_b32 v27, s63, v27
  v_and_b32 v28, s63, v28
  v_and_b32 v29, s63, v29
  v_and_b32 v30, s63, v30
  v_and_b32 v31, s63, v31
  v_and_b32 v32, s63, v32
  v_and_b32 v33, s63, v33
  v_and_b32 v34, s63, v34
  v_and_b32 v35, s63, v35
  v_and_b32 v36, s63, v36
  v_and_b32 v37, s63, v37
  v_and_b32 v38, s63, v38
  v_and_b32 v39, s63, v39
  v_add_f32 v8, v8, v16
  v_add_f32 v24, v24, v32
  v_add_f32 v9, v9, v17
  v_add_f32 v25, v25, v33
  v_add_f32 v10, v10, v18
  v_add_f32 v26, v26, v34
  v_add_f32 v11, v11, v19
  v_add_f32 v27, v27, v35
  v_add_f32 v12, v12, v20
  v_add_f32 v28, v28, v36
  v_add_f32 v13, v13, v21
  v_add_f32 v29, v29, v37
  v_add_f32 v14, v14, v22
  v_add_f32 v30, v30, v38
  v_add_f32 v15, v15, v23
  v_add_f32 v31, v31, v39
  v_add_f32 v8, v8, v24
  v_add_f32 v9, v9, v25
  v_add_f32 v10, v10, v26
  v_add_f32 v11, v11, v27
  v_add_f32 v12, v12, v28
  v_add_f32 v13, v13, v29
  v_add_f32 v14, v14, v30
  v_add_f32 v15, v15, v31
  v_cvt_pk_bf16_f32 v40, v8, v9
  v_cvt_pk_bf16_f32 v41, v10, v11
  v_cvt_pk_bf16_f32 v42, v12, v13
  v_cvt_pk_bf16_f32 v43, v14, v15
  v_lshlrev_b32 v4, 3, v1
  v_add_u32 v4, 159744, v4
  ds_write_b64 v4, v[40:41]
  ds_write_b64 v4, v[42:43] offset:512
  s_mov_b64 exec, 1
  ds_add_u32 v90, v91 offset:0
  s_mov_b64 exec, -1
  s_waitcnt lgkmcnt(0)
  s_endpgm
L_J1:
  s_load_dwordx4 s[8:11], s[0:1], 48
  s_load_dwordx2 s[20:21], s[0:1], 0
  s_mov_b32 s22, 2048
  s_mov_b32 s23, 0x20000
  s_load_dwordx2 s[24:25], s[0:1], 96
  s_mov_b32 s26, 4194304
  s_mov_b32 s27, 0x20000
  s_load_dwordx2 s[28:29], s[0:1], 72
  s_mov_b32 s30, 1024
  s_mov_b32 s31, 0x20000
  s_barrier
  v_and_b32 v1, 63, v0
  v_lshrrev_b32 v2, 4, v1
  v_and_b32 v3, 15, v1
  s_mul_i32 s12, s5, 9363
  s_lshr_b32 s12, s12, 16
  s_mul_i32 s13, s12, 7
  s_sub_u32 s13, s5, s13
  s_and_b32 s14, s12, 1
  s_lshr_b32 s15, s12, 1
  v_mov_b32 v90, 161472
  v_mov_b32 v91, 1
  s_waitcnt lgkmcnt(0)
  s_cmp_eq_u32 s14, 0
  s_cselect_b32 s16, s8, s10
  s_cselect_b32 s17, s9, s11
  s_mov_b32 s18, 1835008
  s_mov_b32 s19, 0x20000
  s_mul_i32 s8, s15, 256*3584
  s_mul_i32 s6, s4, 448
  s_add_u32 s8, s8, s6
  s_lshl_b32 s6, s13, 6
  s_add_u32 s8, s8, s6
  s_cmp_ge_u32 s5, 28
  s_cbranch_scc1 L_nof1_4
  v_lshrrev_b32 v4, 4, v1
  v_lshlrev_b32 v4, 3, v4
  v_bfe_u32 v5, v1, 2, 2
  v_add_u32 v4, v4, v5
  v_mul_u32_u24 v4, 3584, v4
  v_and_b32 v5, 3, v1
  v_bfe_u32 v6, v1, 4, 1
  v_lshlrev_b32 v6, 1, v6
  v_xor_b32 v5, v5, v6
  v_lshlrev_b32 v5, 4, v5
  v_add_u32 v4, v4, v5
  s_mov_b32 m0, 16384
  s_add_u32 s7, s8, 0
  buffer_load_dwordx4 v4, s[16:19], s7 offen nt lds
  s_mov_b32 m0, 17408
  s_add_u32 s7, s8, 14336
  buffer_load_dwordx4 v4, s[16:19], s7 offen nt lds
  s_mov_b32 m0, 18432
  s_add_u32 s7, s8, 114688
  buffer_load_dwordx4 v4, s[16:19], s7 offen nt lds
  s_mov_b32 m0, 19456
  s_add_u32 s7, s8, 129024
  buffer_load_dwordx4 v4, s[16:19], s7 offen nt lds
  s_mov_b32 m0, 20480
  s_add_u32 s7, s8, 229376
  buffer_load_dwordx4 v4, s[16:19], s7 offen nt lds
  s_mov_b32 m0, 21504
  s_add_u32 s7, s8, 243712
  buffer_load_dwordx4 v4, s[16:19], s7 offen nt lds
  s_mov_b32 m0, 22528
  s_add_u32 s7, s8, 344064
  buffer_load_dwordx4 v4, s[16:19], s7 offen nt lds
  s_mov_b32 m0, 23552
  s_add_u32 s7, s8, 358400
  buffer_load_dwordx4 v4, s[16:19], s7 offen nt lds
  s_mov_b32 m0, 24576
  s_add_u32 s7, s8, 458752
  buffer_load_dwordx4 v4, s[16:19], s7 offen nt lds
  s_mov_b32 m0, 25600
  s_add_u32 s7, s8, 473088
  buffer_load_dwordx4 v4, s[16:19], s7 offen nt lds
  s_mov_b32 m0, 26624
  s_add_u32 s7, s8, 573440
  buffer_load_dwordx4 v4, s[16:19], s7 offen nt lds
  s_mov_b32 m0, 27648
  s_add_u32 s7, s8, 587776
  buffer_load_dwordx4 v4, s[16:19], s7 offen nt lds
  s_mov_b32 m0, 28672
  s_add_u32 s7, s8, 688128
  buffer_load_dwordx4 v4, s[16:19], s7 offen nt lds
  s_mov_b32 m0, 29696
  s_add_u32 s7, s8, 702464
  buffer_load_dwordx4 v4, s[16:19], s7 offen nt lds
  s_mov_b32 m0, 30720
  s_add_u32 s7, s8, 802816
  buffer_load_dwordx4 v4, s[16:19], s7 offen nt lds
  s_mov_b32 m0, 31744
  s_add_u32 s7, s8, 817152
  buffer_load_dwordx4 v4, s[16:19], s7 offen nt lds
  v_and_b32 v5, 1, v3
  v_lshlrev_b32 v5, 10, v5
  v_lshlrev_b32 v6, 4, v2
  v_add_u32 v5, v5, v6
  s_lshl_b32 s6, s15, 9
  v_add_u32 v5, s6, v5
  buffer_load_dwordx4 v[96:99], v5, s[20:23], 0 offen offset:0
  buffer_load_dwordx4 v[100:103], v5, s[20:23], 0 offen offset:64
  buffer_load_dwordx4 v[104:107], v5, s[20:23], 0 offen offset:128
  buffer_load_dwordx4 v[108:111], v5, s[20:23], 0 offen offset:192
  buffer_load_dwordx4 v[112:115], v5, s[20:23], 0 offen offset:256
  buffer_load_dwordx4 v[116:119], v5, s[20:23], 0 offen offset:320
  buffer_load_dwordx4 v[120:123], v5, s[20:23], 0 offen offset:384
  buffer_load_dwordx4 v[124:127], v5, s[20:23], 0 offen offset:448
  v_lshrrev_b32 v6, 2, v3
  v_and_b32 v7, 3, v3
  v_lshlrev_b32 v28, 2, v2
  v_add_u32 v28, v28, v6
  v_lshlrev_b32 v28, 6, v28
  v_lshlrev_b32 v7, 3, v7
  v_add_u32 v28, v28, v7
  v_add_u32 v28, 16384, v28
  v_and_b32 v29, 1, v2
  v_lshlrev_b32 v6, 5, v29
  v_add_u32 v24, v28, v6
  v_xor_b32 v6, 1, v29
  v_lshlrev_b32 v6, 5, v6
  v_add_u32 v25, v28, v6
L_nof1_4:
  v_lshlrev_b32 v80, 4, v1
  buffer_load_dwordx4 v[84:87], v80, s[20:23], 0 offen
  buffer_load_dwordx4 v[88:91], v80, s[20:23], 0 offen offset:1024
  buffer_load_dwordx4 v[92:95], v80, s[28:31], 0 offen
  s_load_dword s52, s[24:25], 557056
  s_mov_b32 s53, 0x07060500
  s_mov_b32 s54, 0x07060501
  s_mov_b32 s55, 0x07060502
  s_mov_b32 s56, 0x07060503
  s_mov_b32 s57, 0x0c0c0400
  s_mov_b32 s58, 0x04000c0c
  s_mov_b32 s63, 0xffffff00
  v_and_b32 v81, 3, v1
  v_add_u32 v81, 0x07060500, v81
  s_waitcnt vmcnt(0)
  s_waitcnt lgkmcnt(0)
  s_add_u32 s52, s52, 1
  v_mov_b32 v80, s52
  s_cmp_ge_u32 s5, 28
  s_cbranch_scc1 L_f1j_5
  ds_read_b64_tr_b16 v[32:33], v24 offset:0
  ds_read_b64_tr_b16 v[34:35], v24 offset:1024
  ds_read_b64_tr_b16 v[36:37], v25 offset:0
  ds_read_b64_tr_b16 v[38:39], v25 offset:1024
  ds_read_b64_tr_b16 v[40:41], v24 offset:2048
  ds_read_b64_tr_b16 v[42:43], v24 offset:3072
  ds_read_b64_tr_b16 v[44:45], v25 offset:2048
  ds_read_b64_tr_b16 v[46:47], v25 offset:3072
  s_waitcnt lgkmcnt(0)
  ds_read_b64_tr_b16 v[48:49], v24 offset:4096
  ds_read_b64_tr_b16 v[50:51], v24 offset:5120
  ds_read_b64_tr_b16 v[52:53], v25 offset:4096
  ds_read_b64_tr_b16 v[54:55], v25 offset:5120
  ds_read_b64_tr_b16 v[56:57], v24 offset:6144
  ds_read_b64_tr_b16 v[58:59], v24 offset:7168
  ds_read_b64_tr_b16 v[60:61], v25 offset:6144
  ds_read_b64_tr_b16 v[62:63], v25 offset:7168
  v_mfma_f32_16x16x32_bf16 v[64:67], v[96:99], v[32:35], 0
  v_mfma_f32_16x16x32_bf16 v[68:71], v[96:99], v[36:39], 0
  v_mfma_f32_16x16x32_bf16 v[64:67], v[100:103], v[40:43], v[64:67]
  v_mfma_f32_16x16x32_bf16 v[68:71], v[100:103], v[44:47], v[68:71]
  s_waitcnt lgkmcnt(0)
  ds_read_b64_tr_b16 v[32:33], v24 offset:8192
  ds_read_b64_tr_b16 v[34:35], v24 offset:9216
  ds_read_b64_tr_b16 v[36:37], v25 offset:8192
  ds_read_b64_tr_b16 v[38:39], v25 offset:9216
  ds_read_b64_tr_b16 v[40:41], v24 offset:10240
  ds_read_b64_tr_b16 v[42:43], v24 offset:11264
  ds_read_b64_tr_b16 v[44:45], v25 offset:10240
  ds_read_b64_tr_b16 v[46:47], v25 offset:11264
  v_mfma_f32_16x16x32_bf16 v[64:67], v[104:107], v[48:51], v[64:67]
  v_mfma_f32_16x16x32_bf16 v[68:71], v[104:107], v[52:55], v[68:71]
  v_mfma_f32_16x16x32_bf16 v[64:67], v[108:111], v[56:59], v[64:67]
  v_mfma_f32_16x16x32_bf16 v[68:71], v[108:111], v[60:63], v[68:71]
  s_waitcnt lgkmcnt(0)
  ds_read_b64_tr_b16 v[48:49], v24 offset:12288
  ds_read_b64_tr_b16 v[50:51], v24 offset:13312
  ds_read_b64_tr_b16 v[52:53], v25 offset:12288
  ds_read_b64_tr_b16 v[54:55], v25 offset:13312
  ds_read_b64_tr_b16 v[56:57], v24 offset:14336
  ds_read_b64_tr_b16 v[58:59], v24 offset:15360
  ds_read_b64_tr_b16 v[60:61], v25 offset:14336
  ds_read_b64_tr_b16 v[62:63], v25 offset:15360
  v_mfma_f32_16x16x32_bf16 v[64:67], v[112:115], v[32:35], v[64:67]
  v_mfma_f32_16x16x32_bf16 v[68:71], v[112:115], v[36:39], v[68:71]
  v_mfma_f32_16x16x32_bf16 v[64:67], v[116:119], v[40:43], v[64:67]
  v_mfma_f32_16x16x32_bf16 v[68:71], v[116:119], v[44:47], v[68:71]
  s_waitcnt lgkmcnt(0)
  v_mfma_f32_16x16x32_bf16 v[64:67], v[120:123], v[48:51], v[64:67]
  v_mfma_f32_16x16x32_bf16 v[68:71], v[120:123], v[52:55], v[68:71]
  v_mfma_f32_16x16x32_bf16 v[64:67], v[124:127], v[56:59], v[64:67]
  v_mfma_f32_16x16x32_bf16 v[68:71], v[124:127], v[60:63], v[68:71]
  s_mov_b32 s40, 0xffff0000
  s_mov_b32 s41, 0
  s_mov_b32 s42, 0
  s_mov_b32 s43, 0x0000ffff
  s_mov_b32 s44, 0
  s_mov_b32 s45, 0xffff0000
  s_nop 1
  v_cndmask_b32 v40, v64, v68, s[40:41]
  v_cndmask_b32 v40, v40, v65, s[42:43]
  v_cndmask_b32 v40, v40, v69, s[44:45]
  v_perm_b32 v40, v40, v80, v81
  s_lshl_b32 s6, s4, 2
  s_add_u32 s6, s6, s12
  s_lshl_b32 s6, s4, 2
  s_lshl_b32 s7, s14, 1
  s_add_u32 s6, s6, s7
  s_add_u32 s6, s6, s15
  s_lshl_b32 s6, s6, 11
  s_lshl_b32 s7, s13, 7
  s_add_u32 s6, s6, s7
  s_add_u32 s6, s6, 131072
  v_lshrrev_b32 v4, 5, v1
  v_lshlrev_b32 v4, 10, v4
  v_and_b32 v5, 31, v1
  v_lshlrev_b32 v5, 2, v5
  v_add_u32 v4, v4, v5
  v_add_u32 v4, s6, v4
  s_mov_b32 s7, 262144
  buffer_store_dword v40, v4, s[24:27], 0 offen
  buffer_store_dword v40, v4, s[24:27], s7 offen sc1
L_f1j_5:
  v_mov_b32 v82, 161472
  v_mov_b32 v83, 1
  s_mov_b64 exec, 1
  ds_add_u32 v82, v83 offset:32
  s_mov_b64 exec, -1
  v_mov_b32 v8, 0
  v_mov_b32 v9, 0
  v_lshlrev_b32 v10, 16, v92
  v_and_b32 v11, 0xffff0000, v92
  v_lshlrev_b32 v12, 16, v84
  v_and_b32 v13, 0xffff0000, v84
  v_lshlrev_b32 v14, 16, v88
  v_and_b32 v15, 0xffff0000, v88
  v_fmac_f32 v8, v10, v12
  v_fmac_f32 v9, v10, v14
  v_fmac_f32 v8, v11, v13
  v_fmac_f32 v9, v11, v15
  v_lshlrev_b32 v10, 16, v93
  v_and_b32 v11, 0xffff0000, v93
  v_lshlrev_b32 v12, 16, v85
  v_and_b32 v13, 0xffff0000, v85
  v_lshlrev_b32 v14, 16, v89
  v_and_b32 v15, 0xffff0000, v89
  v_fmac_f32 v8, v10, v12
  v_fmac_f32 v9, v10, v14
  v_fmac_f32 v8, v11, v13
  v_fmac_f32 v9, v11, v15
  v_lshlrev_b32 v10, 16, v94
  v_and_b32 v11, 0xffff0000, v94
  v_lshlrev_b32 v12, 16, v86
  v_and_b32 v13, 0xffff0000, v86
  v_lshlrev_b32 v14, 16, v90
  v_and_b32 v15, 0xffff0000, v90
  v_fmac_f32 v8, v10, v12
  v_fmac_f32 v9, v10, v14
  v_fmac_f32 v8, v11, v13
  v_fmac_f32 v9, v11, v15
  v_lshlrev_b32 v10, 16, v95
  v_and_b32 v11, 0xffff0000, v95
  v_lshlrev_b32 v12, 16, v87
  v_and_b32 v13, 0xffff0000, v87
  v_lshlrev_b32 v14, 16, v91
  v_and_b32 v15, 0xffff0000, v91
  v_fmac_f32 v8, v10, v12
  v_fmac_f32 v9, v10, v14
  v_fmac_f32 v8, v11, v13
  v_fmac_f32 v9, v11, v15
  s_nop 0
  v_add_f32_dpp v8, v8, v8 row_ror:8 row_mask:0xf bank_mask:0xf
  v_add_f32_dpp v9, v9, v9 row_ror:8 row_mask:0xf bank_mask:0xf
  s_nop 0
  v_add_f32_dpp v8, v8, v8 row_ror:4 row_mask:0xf bank_mask:0xf
  v_add_f32_dpp v9, v9, v9 row_ror:4 row_mask:0xf bank_mask:0xf
  s_nop 0
  v_add_f32_dpp v8, v8, v8 row_ror:2 row_mask:0xf bank_mask:0xf
  v_add_f32_dpp v9, v9, v9 row_ror:2 row_mask:0xf bank_mask:0xf
  s_nop 0
  v_add_f32_dpp v8, v8, v8 row_ror:1 row_mask:0xf bank_mask:0xf
  v_add_f32_dpp v9, v9, v9 row_ror:1 row_mask:0xf bank_mask:0xf
  v_mov_b32 v10, v8
  v_mov_b32 v11, v9
  s_nop 0
  v_permlane16_swap_b32 v8, v10
  v_permlane16_swap_b32 v9, v11
  v_add_f32 v8, v8, v10
  v_add_f32 v9, v9, v11
  v_mov_b32 v10, v8
  v_mov_b32 v11, v9
  s_nop 0
  v_permlane32_swap_b32 v8, v10
  v_permlane32_swap_b32 v9, v11
  v_add_f32 v8, v8, v10
  v_add_f32 v9, v9, v11
  v_mul_f32 v8, 0xbfb8aa3b, v8
  v_mul_f32 v9, 0xbfb8aa3b, v9
  v_exp_f32 v8, v8
  v_exp_f32 v9, v9
  v_add_f32 v8, 1.0, v8
  v_add_f32 v9, 1.0, v9
  v_rcp_f32 v8, v8
  v_rcp_f32 v9, v9
  v_mov_b32 v10, 161408
  s_mov_b64 exec, 1
  ds_write_b64 v10, v[8:9]
  s_mov_b64 exec, -1
  s_mov_b32 s40, 0
  s_mov_b32 s41, -1
  v_cndmask_b32 v16, v8, v9, s[40:41]
  v_sub_f32 v16, 1.0, v16
  v_mov_b32 v90, 161472
  v_mov_b32 v91, 1
  s_mov_b64 exec, 1
  ds_add_u32 v90, v91 offset:4
  s_mov_b64 exec, -1
  s_lshl_b32 s6, s4, 13
  s_lshr_b32 s7, s5, 2
  s_mul_i32 s7, s7, 112
  s_add_u32 s6, s6, s7
  s_add_u32 s6, s6, 131072
  v_and_b32 v4, 31, v1
  v_min_u32 v5, 27, v4
  v_and_b32 v17, 3, v5
  v_lshlrev_b32 v17, 3, v17
  v_lshrrev_b32 v17, v17, v80
  v_lshlrev_b32 v5, 2, v5
  v_lshrrev_b32 v6, 5, v1
  v_lshlrev_b32 v6, 10, v6
  v_add_u32 v5, v5, v6
  v_add_u32 v5, s6, v5
  s_mov_b32 s15, 0
  s_mov_b32 s11, 0
L_hg_6:
  s_add_u32 s7, s15, 0
  buffer_load_dword v24, v5, s[24:27], s7 offen sc1
  s_add_u32 s7, s15, 2048
  buffer_load_dword v25, v5, s[24:27], s7 offen sc1
  s_add_u32 s7, s15, 4096
  buffer_load_dword v26, v5, s[24:27], s7 offen sc1
  s_add_u32 s7, s15, 6144
  buffer_load_dword v27, v5, s[24:27], s7 offen sc1
  s_add_u32 s48, s48, 1
  s_add_u32 s11, s11, 1
  s_waitcnt vmcnt(0)
  v_xor_b32 v18, v24, v17
  v_xor_b32 v19, v25, v17
  v_or_b32 v18, v18, v19
  v_xor_b32 v19, v26, v17
  v_or_b32 v18, v18, v19
  v_xor_b32 v19, v27, v17
  v_or_b32 v18, v18, v19
  v_and_b32 v18, 0xff, v18
  v_cmp_ne_u32 vcc, 0, v18
  s_cbranch_vccz L_hgd_7
  s_cmp_gt_u32 s48, 300000
  s_cbranch_scc1 L_hgd_7
  s_sleep 2
  s_cmp_lt_u32 s11, 10
  s_cbranch_scc1 L_hg_6
  s_xor_b32 s15, s15, 262144
  s_branch L_hg_6
L_hgd_7:
  v_and_b32 v24, s63, v24
  v_and_b32 v25, s63, v25
  v_and_b32 v26, s63, v26
  v_and_b32 v27, s63, v27
  v_add_f32 v24, v24, v25
  v_add_f32 v28, v26, v27
  v_mul_f32 v25, 0xbfb8aa3b, v24
  v_exp_f32 v25, v25
  s_nop 0
  v_add_f32 v25, 1.0, v25
  v_rcp_f32 v25, v25
  s_nop 0
  v_mul_f32 v24, v24, v25
  v_mul_f32 v24, v24, v28
  v_mul_f32 v24, v24, v16
  v_cmp_gt_u32 vcc, 28, v4
  s_nop 1
  v_cndmask_b32 v24, 0, v24, vcc
  v_cvt_pk_bf16_f32 v24, v24, v24
  v_bfe_u32 v6, v4, 2, 2
  v_lshlrev_b32 v6, 4, v6
  v_lshrrev_b32 v7, 4, v4
  v_lshlrev_b32 v7, 3, v7
  v_add_u32 v6, v6, v7
  v_and_b32 v7, 3, v4
  v_lshlrev_b32 v7, 1, v7
  v_add_u32 v6, v6, v7
  v_lshrrev_b32 v7, 5, v1
  v_lshlrev_b32 v7, 6, v7
  v_add_u32 v6, v6, v7
  v_add_u32 v6, 161280, v6
  ds_write_b16 v6, v24
  s_waitcnt lgkmcnt(0)
  s_endpgm
L_CW:
  s_load_dwordx2 s[16:17], s[0:1], 8
  s_mov_b32 s18, 33554432
  s_mov_b32 s19, 0x20000
  s_load_dwordx2 s[20:21], s[0:1], 96
  s_mov_b32 s22, 4194304
  s_mov_b32 s23, 0x20000
  s_load_dwordx2 s[24:25], s[0:1], 80
  s_mov_b32 s26, 2048
  s_mov_b32 s27, 0x20000
  s_barrier
  v_and_b32 v1, 63, v0
  v_lshrrev_b32 v2, 4, v1
  v_and_b32 v3, 15, v1
  s_sub_u32 s8, s3, 2
  s_lshr_b32 s6, s5, 4
  s_lshl_b32 s6, s6, 3
  s_add_u32 s6, s6, s4
  s_lshl_b32 s10, s6, 21
  s_and_b32 s6, s5, 15
  s_lshl_b32 s6, s6, 17
  s_add_u32 s10, s10, s6
  s_mul_i32 s6, s5, 1
  s_mul_i32 s7, s4, 0
  s_add_u32 s6, s6, s7
  s_add_u32 s6, s6, s8
  s_and_b32 s6, s6, 7
  s_lshl_b32 s6, s6, 14
  s_add_u32 s10, s10, s6
  v_and_b32 v4, 7, v1
  v_lshlrev_b32 v4, 8, v4
  v_bfe_u32 v5, v1, 3, 1
  v_lshlrev_b32 v5, 6, v5
  v_add_u32 v4, v4, v5
  v_lshlrev_b32 v5, 4, v2
  v_add_u32 v4, v4, v5
  s_mul_i32 s61, s8, 1
  s_mul_i32 s6, s5, 3
  s_add_u32 s61, s61, s6
  s_mul_i32 s6, s4, 0
  s_add_u32 s61, s61, s6
  v_mov_b32 v62, 161472
  v_mov_b32 v63, 1
  s_waitcnt lgkmcnt(0)
  s_add_u32 s11, s61, 0
  s_and_b32 s11, s11, 7
  s_lshl_b32 s11, s11, 11
  s_add_u32 s11, s11, s10
  buffer_load_dwordx4 v[64:67], v4, s[16:19], s11 offen offset:0 nt
  buffer_load_dwordx4 v[68:71], v4, s[16:19], s11 offen offset:128 nt
  s_add_u32 s11, s61, 1
  s_and_b32 s11, s11, 7
  s_lshl_b32 s11, s11, 11
  s_add_u32 s11, s11, s10
  buffer_load_dwordx4 v[72:75], v4, s[16:19], s11 offen offset:0 nt
  buffer_load_dwordx4 v[76:79], v4, s[16:19], s11 offen offset:128 nt
  s_load_dword s52, s[20:21], 557056
  s_mov_b32 s53, 0x07060500
  s_mov_b32 s54, 0x07060501
  s_mov_b32 s55, 0x07060502
  s_mov_b32 s56, 0x07060503
  s_mov_b32 s57, 0x0c0c0400
  s_mov_b32 s58, 0x04000c0c
  s_mov_b32 s63, 0xffffff00
  s_waitcnt vmcnt(3)
  s_add_u32 s11, s61, 2
  s_and_b32 s11, s11, 7
  s_lshl_b32 s11, s11, 11
  s_add_u32 s11, s11, s10
  buffer_load_dwordx4 v[80:83], v4, s[16:19], s11 offen offset:0 nt
  s_waitcnt vmcnt(3)
  buffer_load_dwordx4 v[84:87], v4, s[16:19], s11 offen offset:128 nt
  s_waitcnt vmcnt(3)
  s_add_u32 s11, s61, 3
  s_and_b32 s11, s11, 7
  s_lshl_b32 s11, s11, 11
  s_add_u32 s11, s11, s10
  buffer_load_dwordx4 v[88:91], v4, s[16:19], s11 offen offset:0 nt
  s_waitcnt vmcnt(3)
  buffer_load_dwordx4 v[92:95], v4, s[16:19], s11 offen offset:128 nt
  s_waitcnt vmcnt(3)
  s_add_u32 s11, s61, 4
  s_and_b32 s11, s11, 7
  s_lshl_b32 s11, s11, 11
  s_add_u32 s11, s11, s10
  buffer_load_dwordx4 v[96:99], v4, s[16:19], s11 offen offset:0 nt
  s_waitcnt vmcnt(3)
  buffer_load_dwordx4 v[100:103], v4, s[16:19], s11 offen offset:128 nt
  s_waitcnt vmcnt(3)
  s_add_u32 s11, s61, 5
  s_and_b32 s11, s11, 7
  s_lshl_b32 s11, s11, 11
  s_add_u32 s11, s11, s10
  buffer_load_dwordx4 v[104:107], v4, s[16:19], s11 offen offset:0 nt
  s_waitcnt vmcnt(3)
  buffer_load_dwordx4 v[108:111], v4, s[16:19], s11 offen offset:128 nt
  s_waitcnt vmcnt(3)
  s_add_u32 s11, s61, 6
  s_and_b32 s11, s11, 7
  s_lshl_b32 s11, s11, 11
  s_add_u32 s11, s11, s10
  buffer_load_dwordx4 v[112:115], v4, s[16:19], s11 offen offset:0 nt
  s_waitcnt vmcnt(3)
  buffer_load_dwordx4 v[116:119], v4, s[16:19], s11 offen offset:128 nt
  s_waitcnt vmcnt(3)
  s_add_u32 s11, s61, 7
  s_and_b32 s11, s11, 7
  s_lshl_b32 s11, s11, 11
  s_add_u32 s11, s11, s10
  buffer_load_dwordx4 v[120:123], v4, s[16:19], s11 offen offset:0 nt
  s_waitcnt vmcnt(3)
  buffer_load_dwordx4 v[124:127], v4, s[16:19], s11 offen offset:128 nt
  s_mov_b64 exec, 1
  ds_add_u32 v62, v63 offset:8
  s_mov_b64 exec, -1
  s_waitcnt lgkmcnt(0)
  s_add_u32 s52, s52, 1
  v_and_b32 v5, 3, v3
  v_lshlrev_b32 v6, 8, v5
  v_lshlrev_b32 v7, 4, v2
  v_add_u32 v60, v6, v7
  v_bfe_u32 v6, v3, 3, 1
  v_lshlrev_b32 v6, 6, v6
  v_add_u32 v60, v60, v6
  v_add_u32 v60, 159744, v60
  v_lshlrev_b32 v61, 5, v5
  v_add_u32 v61, 160768, v61
  s_lshl_b32 s6, s8, 2
  v_add_u32 v59, s6, v61
L_lw_8:
  ds_read_b32 v5, v62 offset:0
  s_add_u32 s48, s48, 1
  s_waitcnt lgkmcnt(0)
  v_readfirstlane_b32 s49, v5
  s_nop 0
  s_cmp_ge_u32 s49, 1
  s_cbranch_scc1 L_lwd_9
  s_cmp_gt_u32 s48, 300000
  s_cbranch_scc1 L_lwd_9
  s_sleep 2
  s_branch L_lw_8
L_lwd_9:
  ds_read_b128 v[48:51], v60 offset:0
  ds_read_b128 v[52:55], v60 offset:128
  ds_read_b32 v5, v62 offset:24
  s_waitcnt lgkmcnt(0)
  v_readfirstlane_b32 s51, v5
  s_waitcnt vmcnt(14)
  v_mfma_f32_16x16x32_bf16 v[16:19], v[64:67], v[48:51], 0
  v_mfma_f32_16x16x32_bf16 v[16:19], v[68:71], v[52:55], v[16:19]
  s_waitcnt vmcnt(12)
  v_mfma_f32_16x16x32_bf16 v[20:23], v[72:75], v[48:51], 0
  v_mfma_f32_16x16x32_bf16 v[20:23], v[76:79], v[52:55], v[20:23]
  s_waitcnt vmcnt(10)
  v_mfma_f32_16x16x32_bf16 v[24:27], v[80:83], v[48:51], 0
  v_mfma_f32_16x16x32_bf16 v[24:27], v[84:87], v[52:55], v[24:27]
  s_waitcnt vmcnt(8)
  v_mfma_f32_16x16x32_bf16 v[28:31], v[88:91], v[48:51], 0
  v_mfma_f32_16x16x32_bf16 v[28:31], v[92:95], v[52:55], v[28:31]
  s_waitcnt vmcnt(6)
  v_mfma_f32_16x16x32_bf16 v[32:35], v[96:99], v[48:51], 0
  v_mfma_f32_16x16x32_bf16 v[32:35], v[100:103], v[52:55], v[32:35]
  s_waitcnt vmcnt(4)
  v_mfma_f32_16x16x32_bf16 v[36:39], v[104:107], v[48:51], 0
  v_mfma_f32_16x16x32_bf16 v[36:39], v[108:111], v[52:55], v[36:39]
  s_waitcnt vmcnt(2)
  v_mfma_f32_16x16x32_bf16 v[40:43], v[112:115], v[48:51], 0
  v_mfma_f32_16x16x32_bf16 v[40:43], v[116:119], v[52:55], v[40:43]
  s_waitcnt vmcnt(0)
  v_mfma_f32_16x16x32_bf16 v[44:47], v[120:123], v[48:51], 0
  v_mfma_f32_16x16x32_bf16 v[44:47], v[124:127], v[52:55], v[44:47]
  v_permlane32_swap_b32 v16, v20
  v_permlane32_swap_b32 v17, v21
  v_permlane32_swap_b32 v18, v22
  v_permlane32_swap_b32 v19, v23
  v_add_f32_dpp v16, v20, v16 row_ror:8 row_mask:0xf bank_mask:0xf
  v_add_f32_dpp v17, v21, v17 row_ror:8 row_mask:0xf bank_mask:0xf
  v_add_f32_dpp v18, v22, v18 row_ror:8 row_mask:0xf bank_mask:0xf
  v_add_f32_dpp v19, v23, v19 row_ror:8 row_mask:0xf bank_mask:0xf
  v_permlane32_swap_b32 v24, v28
  v_permlane32_swap_b32 v25, v29
  v_permlane32_swap_b32 v26, v30
  v_permlane32_swap_b32 v27, v31
  v_add_f32_dpp v20, v28, v24 row_ror:8 row_mask:0xf bank_mask:0xf
  v_add_f32_dpp v21, v29, v25 row_ror:8 row_mask:0xf bank_mask:0xf
  v_add_f32_dpp v22, v30, v26 row_ror:8 row_mask:0xf bank_mask:0xf
  v_add_f32_dpp v23, v31, v27 row_ror:8 row_mask:0xf bank_mask:0xf
  v_permlane32_swap_b32 v32, v36
  v_permlane32_swap_b32 v33, v37
  v_permlane32_swap_b32 v34, v38
  v_permlane32_swap_b32 v35, v39
  v_add_f32_dpp v24, v36, v32 row_ror:8 row_mask:0xf bank_mask:0xf
  v_add_f32_dpp v25, v37, v33 row_ror:8 row_mask:0xf bank_mask:0xf
  v_add_f32_dpp v26, v38, v34 row_ror:8 row_mask:0xf bank_mask:0xf
  v_add_f32_dpp v27, v39, v35 row_ror:8 row_mask:0xf bank_mask:0xf
  v_permlane32_swap_b32 v40, v44
  v_permlane32_swap_b32 v41, v45
  v_permlane32_swap_b32 v42, v46
  v_permlane32_swap_b32 v43, v47
  v_add_f32_dpp v28, v44, v40 row_ror:8 row_mask:0xf bank_mask:0xf
  v_add_f32_dpp v29, v45, v41 row_ror:8 row_mask:0xf bank_mask:0xf
  v_add_f32_dpp v30, v46, v42 row_ror:8 row_mask:0xf bank_mask:0xf
  v_add_f32_dpp v31, v47, v43 row_ror:8 row_mask:0xf bank_mask:0xf
  v_max3_f32 v5, v16, v17, v18
  v_max3_f32 v5, v5, v19, v20
  v_max3_f32 v5, v5, v21, v22
  v_max3_f32 v5, v5, v23, v24
  v_max3_f32 v5, v5, v25, v26
  v_max3_f32 v5, v5, v27, v28
  v_max3_f32 v5, v5, v29, v30
  v_max_f32 v5, v5, v31
  v_mov_b32 v6, v5
  s_nop 1
  v_permlane16_swap_b32 v5, v6
  v_max_f32 v5, v5, v6
  v_mov_b32 v6, v5
  s_nop 1
  v_permlane32_swap_b32 v5, v6
  v_max_f32 v5, v5, v6
  s_mov_b64 exec, 15
  ds_write_b32 v59, v5
  s_mov_b64 exec, -1
  s_mov_b64 exec, 1
  ds_add_u32 v62, v63 offset:12
  s_mov_b64 exec, -1
L_lw_10:
  ds_read_b32 v6, v62 offset:12
  s_add_u32 s48, s48, 1
  s_waitcnt lgkmcnt(0)
  v_readfirstlane_b32 s49, v6
  s_nop 0
  s_cmp_ge_u32 s49, 8
  s_cbranch_scc1 L_lwd_11
  s_cmp_gt_u32 s48, 300000
  s_cbranch_scc1 L_lwd_11
  s_branch L_lw_10
L_lwd_11:
  ds_read_b128 v[48:51], v61
  ds_read_b128 v[52:55], v61 offset:16
  s_mov_b32 s50, 0x3e0293ee
  s_waitcnt lgkmcnt(0)
  v_max3_f32 v48, v48, v49, v50
  v_max3_f32 v51, v51, v52, v53
  v_max3_f32 v48, v48, v54, v55
  v_max_f32 v48, v48, v51
  v_mul_f32 v58, s50, v48
  v_and_b32 v58, s63, v58
  v_fma_f32 v16, v16, s50, -v58
  v_fma_f32 v17, v17, s50, -v58
  v_fma_f32 v18, v18, s50, -v58
  v_fma_f32 v19, v19, s50, -v58
  v_fma_f32 v20, v20, s50, -v58
  v_fma_f32 v21, v21, s50, -v58
  v_fma_f32 v22, v22, s50, -v58
  v_fma_f32 v23, v23, s50, -v58
  v_fma_f32 v24, v24, s50, -v58
  v_fma_f32 v25, v25, s50, -v58
  v_fma_f32 v26, v26, s50, -v58
  v_fma_f32 v27, v27, s50, -v58
  v_fma_f32 v28, v28, s50, -v58
  v_fma_f32 v29, v29, s50, -v58
  v_fma_f32 v30, v30, s50, -v58
  v_fma_f32 v31, v31, s50, -v58
  v_exp_f32 v16, v16
  v_exp_f32 v17, v17
  v_exp_f32 v18, v18
  v_exp_f32 v19, v19
  v_exp_f32 v20, v20
  v_exp_f32 v21, v21
  v_exp_f32 v22, v22
  v_exp_f32 v23, v23
  v_exp_f32 v24, v24
  v_exp_f32 v25, v25
  v_exp_f32 v26, v26
  v_exp_f32 v27, v27
  v_exp_f32 v28, v28
  v_exp_f32 v29, v29
  v_exp_f32 v30, v30
  v_exp_f32 v31, v31
  v_cvt_pk_bf16_f32 v48, v16, v17
  v_cvt_pk_bf16_f32 v49, v18, v19
  v_cvt_pk_bf16_f32 v50, v20, v21
  v_cvt_pk_bf16_f32 v51, v22, v23
  v_cvt_pk_bf16_f32 v52, v24, v25
  v_cvt_pk_bf16_f32 v53, v26, v27
  v_cvt_pk_bf16_f32 v54, v28, v29
  v_cvt_pk_bf16_f32 v55, v30, v31
  s_lshl_b32 s6, s8, 9
  s_add_u32 s6, s6, 155648
  v_lshlrev_b32 v6, 6, v2
  v_lshlrev_b32 v7, 4, v3
  v_add_u32 v6, v6, v7
  v_add_u32 v6, s6, v6
  s_mov_b32 s40, 0x000f000f
  s_mov_b32 s41, 0x000f000f
  s_mov_b64 exec, s[40:41]
  ds_write_b128 v6, v[48:51]
  ds_write_b128 v6, v[52:55] offset:256
  s_mov_b64 exec, -1
  v_add_f32 v16, v16, v24
  v_add_f32 v17, v17, v25
  v_add_f32 v18, v18, v26
  v_add_f32 v19, v19, v27
  v_add_f32 v20, v20, v28
  v_add_f32 v21, v21, v29
  v_add_f32 v22, v22, v30
  v_add_f32 v23, v23, v31
  v_add_f32 v16, v16, v20
  v_add_f32 v17, v17, v21
  v_add_f32 v18, v18, v22
  v_add_f32 v19, v19, v23
  v_add_f32 v16, v16, v17
  v_add_f32 v18, v18, v19
  v_add_f32 v5, v16, v18
  v_mov_b32 v6, v5
  s_nop 1
  v_permlane16_swap_b32 v5, v6
  v_add_f32 v5, v5, v6
  v_mov_b32 v6, v5
  s_nop 1
  v_permlane32_swap_b32 v5, v6
  v_add_f32 v5, v5, v6
  s_mov_b64 exec, 15
  ds_write_b32 v59, v5 offset:128
  s_mov_b64 exec, -1
  s_mov_b64 exec, 1
  ds_add_u32 v62, v63 offset:16
  s_mov_b64 exec, -1
L_lw_12:
  ds_read_b32 v6, v62 offset:16
  s_add_u32 s48, s48, 1
  s_waitcnt lgkmcnt(0)
  v_readfirstlane_b32 s49, v6
  s_nop 0
  s_cmp_ge_u32 s49, 8
  s_cbranch_scc1 L_lwd_13
  s_cmp_gt_u32 s48, 300000
  s_cbranch_scc1 L_lwd_13
  s_branch L_lw_12
L_lwd_13:
  s_lshl_b32 s12, s4, 5
  s_add_u32 s12, s12, s5
  v_mov_b32 v47, s52
  s_cmp_lg_u32 s8, 0
  s_cbranch_scc1 L_nostat_14
  ds_read_b128 v[48:51], v61 offset:128
  ds_read_b128 v[52:55], v61 offset:144
  v_and_b32 v6, 3, v1
  v_add_u32 v6, 0x07060500, v6
  s_waitcnt lgkmcnt(0)
  v_add_f32 v48, v48, v49
  v_add_f32 v50, v50, v51
  v_add_f32 v52, v52, v53
  v_add_f32 v54, v54, v55
  v_add_f32 v48, v48, v50
  v_add_f32 v52, v52, v54
  v_add_f32 v48, v48, v52
  s_mov_b32 s40, 0xf0f0f0f0
  s_mov_b32 s41, 0
  v_cndmask_b32 v48, v58, v48, s[40:41]
  v_perm_b32 v48, v48, v47, v6
  s_lshl_b32 s6, s12, 7
  s_add_u32 s6, s6, 524288
  v_lshlrev_b32 v6, 2, v1
  s_mov_b32 exec_hi, 0
  s_cmp_eq_u32 s51, 0
  s_cbranch_scc1 L_ms_15
  buffer_store_dword v48, v6, s[20:23], s6 offen
  s_branch L_mse_16
L_ms_15:
  buffer_store_dword v48, v6, s[20:23], s6 offen sc1
L_mse_16:
  s_mov_b32 exec_hi, -1
L_nostat_14:
  v_and_b32 v5, 3, v3
  v_lshlrev_b32 v5, 4, v5
  v_lshlrev_b32 v6, 6, v2
  v_add_u32 v5, v5, v6
  v_add_u32 v5, 155648, v5
  ds_read_b128 v[64:67], v5 offset:0
  ds_read_b128 v[68:71], v5 offset:256
  ds_read_b128 v[72:75], v5 offset:512
  ds_read_b128 v[76:79], v5 offset:768
  ds_read_b128 v[80:83], v5 offset:1024
  ds_read_b128 v[84:87], v5 offset:1280
  ds_read_b128 v[88:91], v5 offset:1536
  ds_read_b128 v[92:95], v5 offset:1792
  s_waitcnt lgkmcnt(0)
  ds_read_b128 v[96:99], v5 offset:2048
  ds_read_b128 v[100:103], v5 offset:2304
  ds_read_b128 v[104:107], v5 offset:2560
  ds_read_b128 v[108:111], v5 offset:2816
  ds_read_b128 v[112:115], v5 offset:3072
  ds_read_b128 v[116:119], v5 offset:3328
  ds_read_b128 v[120:123], v5 offset:3584
  ds_read_b128 v[124:127], v5 offset:3840
  v_lshrrev_b32 v5, 2, v3
  v_and_b32 v6, 3, v3
  v_lshlrev_b32 v7, 2, v2
  v_add_u32 v7, v7, v5
  v_and_b32 v48, 7, v7
  v_xor_b32 v48, s8, v48
  v_lshlrev_b32 v48, 5, v48
  v_lshlrev_b32 v7, 8, v7
  v_add_u32 v7, v7, v48
  v_lshlrev_b32 v6, 3, v6
  v_add_u32 v56, v7, v6
  v_add_u32 v57, 0x10000, v56
  v_add_u32 v59, 0x20000, v56
  s_lshr_b32 s13, s5, 2
  s_and_b32 s14, s5, 3
  s_and_b32 s15, s8, 1
  s_lshl_b32 s6, s15, 4
  v_add_u32 v5, s6, v2
  v_lshlrev_b32 v12, 4, v5
  v_add_u32 v12, 161792, v12
  s_lshl_b32 s6, s4, 5
  v_add_u32 v61, s6, v5
  v_lshlrev_b32 v61, 11, v61
  s_lshl_b32 s6, s13, 4
  v_add_u32 v6, s6, v3
  v_lshlrev_b32 v6, 4, v6
  v_add_u32 v61, v61, v6
  v_add_u32 v61, 1048576, v61
  v_lshrrev_b32 v6, 3, v3
  v_lshlrev_b32 v6, 6, v6
  v_bfe_u32 v7, v3, 2, 1
  v_lshlrev_b32 v7, 3, v7
  v_add_u32 v6, v6, v7
  v_and_b32 v7, 3, v3
  v_lshlrev_b32 v7, 4, v7
  v_add_u32 v6, v6, v7
  v_lshlrev_b32 v7, 1, v2
  v_add_u32 v6, v6, v7
  s_lshl_b32 s6, s15, 7
  s_add_u32 s6, s6, 161024
  v_add_u32 v60, s6, v6
  s_lshl_b32 s6, s12, 11
  s_lshl_b32 s7, s8, 8
  s_add_u32 s6, s6, s7
  s_add_u32 s6, s6, 1048576
  v_lshlrev_b32 v58, 4, v3
  v_add_u32 v58, s6, v58
  v_and_b32 v6, 1, v3
  v_lshlrev_b32 v44, 1, v6
  v_add_u32 v50, 0x07060500, v44
  v_add_u32 v51, 1, v50
  v_mov_b32 v49, s52
  v_lshlrev_b32 v7, 6, v6
  v_lshlrev_b32 v6, 7, v6
  v_lshlrev_b32 v48, 4, v2
  v_add_u32 v6, v6, v48
  v_add_u32 v62, 161024, v6
  v_add_u32 v7, v7, v48
  v_add_u32 v48, 161280, v7
  s_lshl_b32 s6, s14, 3
  s_add_u32 s6, s6, s8
  s_lshl_b32 s6, s6, 6
  s_lshl_b32 s7, s4, 3
  s_add_u32 s7, s7, s13
  s_add_u32 s6, s6, s7
  s_lshl_b32 s6, s6, 7
  s_add_u32 s6, s6, 1572864
  v_lshlrev_b32 v63, 3, v3
  v_add_u32 v63, s6, v63
  v_mov_b32 v13, 161472
  s_and_b32 s13, s2, 3
  s_lshr_b32 s14, s2, 2
  s_lshl_b32 s6, s13, 3
  s_add_u32 s6, s6, s14
  s_lshl_b32 s6, s6, 13
  s_lshl_b32 s7, s8, 5
  s_add_u32 s6, s6, s7
  s_add_u32 s6, s6, 1572864
  v_lshrrev_b32 v14, 1, v1
  v_lshlrev_b32 v14, 7, v14
  v_and_b32 v6, 1, v1
  v_lshlrev_b32 v7, 4, v6
  v_add_u32 v14, v14, v7
  v_add_u32 v14, s6, v14
  s_lshl_b32 s6, s13, 8
  s_lshl_b32 s7, s14, 5
  s_add_u32 s6, s6, s7
  s_lshl_b32 s7, s8, 3
  s_add_u32 s6, s6, s7
  v_and_b32 v15, 1, v2
  v_lshlrev_b32 v15, 10, v15
  v_lshlrev_b32 v6, 2, v6
  v_add_u32 v15, v15, v6
  v_lshrrev_b32 v6, 1, v2
  v_lshlrev_b32 v6, 1, v6
  v_add_u32 v15, v15, v6
  v_add_u32 v15, s6, v15
  s_waitcnt lgkmcnt(0)
  s_mov_b32 s60, 0
  s_cmp_lg_u32 s8, 2
  s_cbranch_scc1 L_sa_17
L_lw_18:
  ds_read_b32 v5, v13 offset:4
  s_add_u32 s48, s48, 1
  s_waitcnt lgkmcnt(0)
  v_readfirstlane_b32 s49, v5
  s_nop 0
  s_cmp_ge_u32 s49, 1
  s_cbranch_scc1 L_lwd_19
  s_cmp_gt_u32 s48, 300000
  s_cbranch_scc1 L_lwd_19
  s_sleep 1
  s_branch L_lw_18
L_lwd_19:
  v_mov_b32 v5, 161408
  ds_read_b64 v[6:7], v5
  s_mov_b32 s40, 0
  s_mov_b32 s41, -1
  v_lshrrev_b32 v5, 5, v1
  v_lshlrev_b32 v5, 4, v5
  v_add_u32 v5, v5, v3
  v_lshlrev_b32 v60, 4, v5
  v_add_u32 v60, 161792, v60
  s_lshl_b32 s6, s4, 5
  v_add_u32 v5, s6, v5
  v_lshlrev_b32 v5, 7, v5
  v_add_u32 v61, 524288, v5
  s_waitcnt lgkmcnt(0)
  v_cndmask_b32 v12, v6, v7, s[40:41]
L_sa_17:
L_lw_20:
  ds_read_b32 v5, v13 offset:20
  s_add_u32 s48, s48, 1
  s_waitcnt lgkmcnt(0)
  v_readfirstlane_b32 s49, v5
  s_nop 0
  s_cmp_ge_u32 s49, 4
  s_cbranch_scc1 L_lwd_21
  s_cmp_gt_u32 s48, 300000
  s_cbranch_scc1 L_lwd_21
  s_sleep 1
  s_branch L_lw_20
L_lwd_21:
  ds_read_b64_tr_b16 v[16:17], v56 offset:0
  ds_read_b64_tr_b16 v[18:19], v56 offset:4096
  ds_read_b64_tr_b16 v[20:21], v56 offset:8192
  ds_read_b64_tr_b16 v[22:23], v56 offset:12288
  ds_read_b64_tr_b16 v[24:25], v56 offset:16384
  ds_read_b64_tr_b16 v[26:27], v56 offset:20480
  ds_read_b64_tr_b16 v[28:29], v56 offset:24576
  ds_read_b64_tr_b16 v[30:31], v56 offset:28672
  s_waitcnt lgkmcnt(0)
  ds_read_b64_tr_b16 v[32:33], v56 offset:32768
  ds_read_b64_tr_b16 v[34:35], v56 offset:36864
  ds_read_b64_tr_b16 v[36:37], v56 offset:40960
  ds_read_b64_tr_b16 v[38:39], v56 offset:45056
  ds_read_b64_tr_b16 v[40:41], v56 offset:49152
  ds_read_b64_tr_b16 v[42:43], v56 offset:53248
  ds_read_b64_tr_b16 v[44:45], v56 offset:57344
  ds_read_b64_tr_b16 v[46:47], v56 offset:61440
  v_mfma_f32_16x16x32_bf16 v[8:11], v[64:67], v[16:19], 0
  v_mfma_f32_16x16x32_bf16 v[8:11], v[68:71], v[20:23], v[8:11]
  v_mfma_f32_16x16x32_bf16 v[8:11], v[72:75], v[24:27], v[8:11]
  v_mfma_f32_16x16x32_bf16 v[8:11], v[76:79], v[28:31], v[8:11]
  s_cmp_lg_u32 s8, 2
  s_cbranch_scc1 L_nsl_22
  buffer_load_dwordx4 v[64:67], v61, s[20:23], 0 offen sc1
  buffer_load_dwordx4 v[68:71], v61, s[20:23], 0 offen offset:16 sc1
L_nsl_22:
  s_waitcnt lgkmcnt(0)
  ds_read_b64_tr_b16 v[16:17], v57 offset:0
  ds_read_b64_tr_b16 v[18:19], v57 offset:4096
  ds_read_b64_tr_b16 v[20:21], v57 offset:8192
  ds_read_b64_tr_b16 v[22:23], v57 offset:12288
  ds_read_b64_tr_b16 v[24:25], v57 offset:16384
  ds_read_b64_tr_b16 v[26:27], v57 offset:20480
  ds_read_b64_tr_b16 v[28:29], v57 offset:24576
  ds_read_b64_tr_b16 v[30:31], v57 offset:28672
  v_mfma_f32_16x16x32_bf16 v[8:11], v[80:83], v[32:35], v[8:11]
  v_mfma_f32_16x16x32_bf16 v[8:11], v[84:87], v[36:39], v[8:11]
  v_mfma_f32_16x16x32_bf16 v[8:11], v[88:91], v[40:43], v[8:11]
  v_mfma_f32_16x16x32_bf16 v[8:11], v[92:95], v[44:47], v[8:11]
  s_waitcnt lgkmcnt(0)
  ds_read_b64_tr_b16 v[32:33], v57 offset:32768
  ds_read_b64_tr_b16 v[34:35], v57 offset:36864
  ds_read_b64_tr_b16 v[36:37], v57 offset:40960
  ds_read_b64_tr_b16 v[38:39], v57 offset:45056
  v_mfma_f32_16x16x32_bf16 v[8:11], v[96:99], v[16:19], v[8:11]
  v_mfma_f32_16x16x32_bf16 v[8:11], v[100:103], v[20:23], v[8:11]
  v_mfma_f32_16x16x32_bf16 v[8:11], v[104:107], v[24:27], v[8:11]
  v_mfma_f32_16x16x32_bf16 v[8:11], v[108:111], v[28:31], v[8:11]
  s_waitcnt lgkmcnt(0)
  v_mfma_f32_16x16x32_bf16 v[8:11], v[112:115], v[32:35], v[8:11]
  v_mfma_f32_16x16x32_bf16 v[8:11], v[116:119], v[36:39], v[8:11]
  s_barrier
  ds_read_b64_tr_b16 v[16:17], v57 offset:49152
  ds_read_b64_tr_b16 v[18:19], v57 offset:53248
  ds_read_b64_tr_b16 v[20:21], v57 offset:57344
  ds_read_b64_tr_b16 v[22:23], v57 offset:61440
  s_waitcnt lgkmcnt(2)
  v_mfma_f32_16x16x32_bf16 v[8:11], v[120:123], v[16:19], v[8:11]
  s_waitcnt lgkmcnt(0)
  v_mfma_f32_16x16x32_bf16 v[8:11], v[124:127], v[20:23], v[8:11]
  s_nop 7
  v_perm_b32 v8, v8, v49, s53
  v_perm_b32 v9, v9, v49, s54
  v_perm_b32 v10, v10, v49, s55
  v_perm_b32 v11, v11, v49, s56
  s_mov_b64 exec, 0xffff
  s_cmp_eq_u32 s51, 0
  s_cbranch_scc1 L_ms_23
  buffer_store_dwordx4 v[8:11], v58, s[20:23], 0 offen
  s_branch L_mse_24
L_ms_23:
  buffer_store_dwordx4 v[8:11], v58, s[20:23], 0 offen sc1
L_mse_24:
  s_mov_b64 exec, -1
  ds_read_b128 v[52:55], v48
  s_cmp_lg_u32 s8, 2
  s_cbranch_scc1 L_nsw_25
  s_waitcnt vmcnt(1)
  v_perm_b32 v7, v65, v64, s57
  v_perm_b32 v4, v67, v66, s58
  v_or_b32 v7, v7, v4
  v_xor_b32 v5, s52, v7
  v_perm_b32 v7, v69, v68, s57
  v_perm_b32 v4, v71, v70, s58
  v_or_b32 v7, v7, v4
  v_xor_b32 v6, s52, v7
  v_or_b32 v5, v5, v6
  v_cmp_ne_u32 vcc, 0, v5
  s_cbranch_vccz L_sw_26
L_swr_27:
  buffer_load_dwordx4 v[64:67], v61, s[20:23], 0 offen sc1
  buffer_load_dwordx4 v[68:71], v61, s[20:23], 0 offen offset:16 sc1
  s_add_u32 s48, s48, 1
  s_waitcnt vmcnt(0)
  v_perm_b32 v7, v65, v64, s57
  v_perm_b32 v4, v67, v66, s58
  v_or_b32 v7, v7, v4
  v_xor_b32 v5, s52, v7
  v_perm_b32 v7, v69, v68, s57
  v_perm_b32 v4, v71, v70, s58
  v_or_b32 v7, v7, v4
  v_xor_b32 v6, s52, v7
  v_or_b32 v5, v5, v6
  v_cmp_ne_u32 vcc, 0, v5
  s_cbranch_vccz L_sw_26
  s_cmp_gt_u32 s48, 300000
  s_cbranch_scc1 L_sw_26
  s_sleep 2
  s_branch L_swr_27
L_sw_26:
  v_and_b32 v64, s63, v64
  v_and_b32 v65, s63, v65
  v_and_b32 v66, s63, v66
  v_and_b32 v67, s63, v67
  v_and_b32 v68, s63, v68
  v_and_b32 v69, s63, v69
  v_and_b32 v70, s63, v70
  v_and_b32 v71, s63, v71
  v_mov_b32 v72, v64
  v_mov_b32 v73, v65
  v_mov_b32 v74, v66
  v_mov_b32 v75, v67
  v_max_f32_dpp v72, v72, v72 row_ror:8 row_mask:0xf bank_mask:0xf
  v_max_f32_dpp v73, v73, v73 row_ror:8 row_mask:0xf bank_mask:0xf
  v_max_f32_dpp v74, v74, v74 row_ror:8 row_mask:0xf bank_mask:0xf
  v_max_f32_dpp v75, v75, v75 row_ror:8 row_mask:0xf bank_mask:0xf
  v_max_f32_dpp v72, v72, v72 row_ror:4 row_mask:0xf bank_mask:0xf
  v_max_f32_dpp v73, v73, v73 row_ror:4 row_mask:0xf bank_mask:0xf
  v_max_f32_dpp v74, v74, v74 row_ror:4 row_mask:0xf bank_mask:0xf
  v_max_f32_dpp v75, v75, v75 row_ror:4 row_mask:0xf bank_mask:0xf
  v_max_f32_dpp v72, v72, v72 row_ror:2 row_mask:0xf bank_mask:0xf
  v_max_f32_dpp v73, v73, v73 row_ror:2 row_mask:0xf bank_mask:0xf
  v_max_f32_dpp v74, v74, v74 row_ror:2 row_mask:0xf bank_mask:0xf
  v_max_f32_dpp v75, v75, v75 row_ror:2 row_mask:0xf bank_mask:0xf
  v_max_f32_dpp v72, v72, v72 row_ror:1 row_mask:0xf bank_mask:0xf
  v_max_f32_dpp v73, v73, v73 row_ror:1 row_mask:0xf bank_mask:0xf
  v_max_f32_dpp v74, v74, v74 row_ror:1 row_mask:0xf bank_mask:0xf
  v_max_f32_dpp v75, v75, v75 row_ror:1 row_mask:0xf bank_mask:0xf
  v_sub_f32 v64, v64, v72
  v_sub_f32 v65, v65, v73
  v_sub_f32 v66, v66, v74
  v_sub_f32 v67, v67, v75
  v_exp_f32 v64, v64
  v_exp_f32 v65, v65
  v_exp_f32 v66, v66
  v_exp_f32 v67, v67
  v_mul_f32 v68, v68, v64
  v_mul_f32 v69, v69, v65
  v_mul_f32 v70, v70, v66
  v_mul_f32 v71, v71, v67
  v_add_f32_dpp v68, v68, v68 row_ror:8 row_mask:0xf bank_mask:0xf
  v_add_f32_dpp v69, v69, v69 row_ror:8 row_mask:0xf bank_mask:0xf
  v_add_f32_dpp v70, v70, v70 row_ror:8 row_mask:0xf bank_mask:0xf
  v_add_f32_dpp v71, v71, v71 row_ror:8 row_mask:0xf bank_mask:0xf
  v_add_f32_dpp v68, v68, v68 row_ror:4 row_mask:0xf bank_mask:0xf
  v_add_f32_dpp v69, v69, v69 row_ror:4 row_mask:0xf bank_mask:0xf
  v_add_f32_dpp v70, v70, v70 row_ror:4 row_mask:0xf bank_mask:0xf
  v_add_f32_dpp v71, v71, v71 row_ror:4 row_mask:0xf bank_mask:0xf
  v_add_f32_dpp v68, v68, v68 row_ror:2 row_mask:0xf bank_mask:0xf
  v_add_f32_dpp v69, v69, v69 row_ror:2 row_mask:0xf bank_mask:0xf
  v_add_f32_dpp v70, v70, v70 row_ror:2 row_mask:0xf bank_mask:0xf
  v_add_f32_dpp v71, v71, v71 row_ror:2 row_mask:0xf bank_mask:0xf
  v_add_f32_dpp v68, v68, v68 row_ror:1 row_mask:0xf bank_mask:0xf
  v_add_f32_dpp v69, v69, v69 row_ror:1 row_mask:0xf bank_mask:0xf
  v_add_f32_dpp v70, v70, v70 row_ror:1 row_mask:0xf bank_mask:0xf
  v_add_f32_dpp v71, v71, v71 row_ror:1 row_mask:0xf bank_mask:0xf
  v_rcp_f32 v68, v68
  v_rcp_f32 v69, v69
  v_rcp_f32 v70, v70
  v_rcp_f32 v71, v71
  v_mul_f32 v64, v64, v12
  v_mul_f32 v65, v65, v12
  v_mul_f32 v66, v66, v12
  v_mul_f32 v67, v67, v12
  v_mul_f32 v64, v64, v68
  v_mul_f32 v65, v65, v69
  v_mul_f32 v66, v66, v70
  v_mul_f32 v67, v67, v71
  ds_write_b128 v60, v[64:67]
  v_mov_b32 v5, 1
  s_mov_b64 exec, 1
  ds_add_u32 v13, v5 offset:28
  s_mov_b64 exec, -1
L_nsw_25:
  s_cmp_gt_u32 s8, 1
  s_cbranch_scc1 L_nog_28
  s_mov_b32 s6, 8192
  s_mov_b32 s7, 16384
  s_mov_b32 s9, 24576
  buffer_load_dwordx4 v[64:67], v61, s[20:23], 0 offen sc1
  buffer_load_dwordx4 v[68:71], v61, s[20:23], s6 offen sc1
  buffer_load_dwordx4 v[72:75], v61, s[20:23], s7 offen sc1
  buffer_load_dwordx4 v[76:79], v61, s[20:23], s9 offen sc1
L_lw_29:
  ds_read_b32 v5, v13 offset:28
  s_add_u32 s48, s48, 1
  s_waitcnt lgkmcnt(0)
  v_readfirstlane_b32 s49, v5
  s_nop 0
  s_cmp_ge_u32 s49, 1
  s_cbranch_scc1 L_lwd_30
  s_cmp_gt_u32 s48, 300000
  s_cbranch_scc1 L_lwd_30
  s_branch L_lw_29
L_lwd_30:
  ds_read_b128 v[80:83], v12 offset:0
  ds_read_b128 v[84:87], v12 offset:64
  ds_read_b128 v[88:91], v12 offset:128
  ds_read_b128 v[92:95], v12 offset:192
L_t2_31:
  s_waitcnt vmcnt(3)
  v_perm_b32 v18, v65, v64, s57
  v_perm_b32 v19, v67, v66, s58
  v_or_b32 v18, v18, v19
  v_xor_b32 v16, s52, v18
  s_waitcnt vmcnt(2)
  v_perm_b32 v18, v69, v68, s57
  v_perm_b32 v19, v71, v70, s58
  v_or_b32 v18, v18, v19
  v_xor_b32 v17, s52, v18
  v_or_b32 v16, v16, v17
  s_waitcnt vmcnt(1)
  v_perm_b32 v18, v73, v72, s57
  v_perm_b32 v19, v75, v74, s58
  v_or_b32 v18, v18, v19
  v_xor_b32 v17, s52, v18
  v_or_b32 v16, v16, v17
  s_waitcnt vmcnt(0)
  v_perm_b32 v18, v77, v76, s57
  v_perm_b32 v19, v79, v78, s58
  v_or_b32 v18, v18, v19
  v_xor_b32 v17, s52, v18
  v_or_b32 v16, v16, v17
  v_cmp_ne_u32 vcc, 0, v16
  s_cbranch_vccz L_t2h_33
  buffer_load_dwordx4 v[64:67], v61, s[20:23], 0 offen sc1
  buffer_load_dwordx4 v[68:71], v61, s[20:23], s6 offen sc1
  buffer_load_dwordx4 v[72:75], v61, s[20:23], s7 offen sc1
  buffer_load_dwordx4 v[76:79], v61, s[20:23], s9 offen sc1
  s_add_u32 s48, s48, 1
  s_cmp_le_u32 s48, 300000
  s_cbranch_scc1 L_t2_31
L_t2h_33:
  v_and_b32 v64, s63, v64
  v_and_b32 v65, s63, v65
  v_and_b32 v66, s63, v66
  v_and_b32 v67, s63, v67
  v_and_b32 v68, s63, v68
  v_and_b32 v69, s63, v69
  v_and_b32 v70, s63, v70
  v_and_b32 v71, s63, v71
  v_and_b32 v72, s63, v72
  v_and_b32 v73, s63, v73
  v_and_b32 v74, s63, v74
  v_and_b32 v75, s63, v75
  v_and_b32 v76, s63, v76
  v_and_b32 v77, s63, v77
  v_and_b32 v78, s63, v78
  v_and_b32 v79, s63, v79
  s_waitcnt lgkmcnt(0)
  v_mul_f32 v16, v64, v80
  v_mul_f32 v17, v65, v81
  v_mul_f32 v18, v66, v82
  v_mul_f32 v19, v67, v83
  v_fmac_f32 v16, v68, v84
  v_fmac_f32 v17, v69, v85
  v_fmac_f32 v18, v70, v86
  v_fmac_f32 v19, v71, v87
  v_fmac_f32 v16, v72, v88
  v_fmac_f32 v17, v73, v89
  v_fmac_f32 v18, v74, v90
  v_fmac_f32 v19, v75, v91
  v_fmac_f32 v16, v76, v92
  v_fmac_f32 v17, v77, v93
  v_fmac_f32 v18, v78, v94
  v_fmac_f32 v19, v79, v95
L_t2d_32:
  v_permlane16_swap_b32 v16, v17
  s_nop 0
  v_permlane16_swap_b32 v18, v19
  v_add_f32 v16, v16, v17
  v_add_f32 v18, v18, v19
  s_nop 1
  v_permlane32_swap_b32 v16, v18
  v_add_f32 v16, v16, v18
  v_cvt_pk_bf16_f32 v16, v16, v16
  ds_write_b16 v60, v16
  s_waitcnt lgkmcnt(0)
L_nog_28:
  s_barrier
  ds_read_b64_tr_b16 v[16:17], v59 offset:16384
  ds_read_b64_tr_b16 v[18:19], v59 offset:20480
  ds_read_b128 v[32:35], v62
  ds_read_b64_tr_b16 v[20:21], v59
  ds_read_b64_tr_b16 v[22:23], v59 offset:4096
  ds_read_b128 v[36:39], v62 offset:64
  ds_read_b64_tr_b16 v[24:25], v59 offset:8192
  ds_read_b64_tr_b16 v[26:27], v59 offset:12288
  s_waitcnt lgkmcnt(6)
  v_mfma_f32_16x16x32_bf16 v[8:11], v[52:55], v[16:19], 0
  s_waitcnt lgkmcnt(3)
  v_mfma_f32_16x16x32_bf16 v[8:11], v[32:35], v[20:23], v[8:11]
  s_waitcnt lgkmcnt(0)
  v_mfma_f32_16x16x32_bf16 v[8:11], v[36:39], v[24:27], v[8:11]
  s_nop 7
  v_perm_b32 v8, v8, v49, v50
  v_perm_b32 v9, v9, v49, v51
  s_mov_b64 exec, 0xffff
  buffer_store_dwordx2 v[8:9], v63, s[20:23], 0 offen sc1
  s_mov_b64 exec, -1
  s_cmp_ge_u32 s2, 32
  s_cbranch_scc1 L_CW_end
  s_cmp_gt_u32 s8, 3
  s_cbranch_scc1 L_CW_end
  s_mov_b32 s7, 4096
  s_waitcnt vmcnt(0)
  buffer_load_dwordx4 v[64:67], v14, s[20:23], 0 offen sc1
  buffer_load_dwordx4 v[68:71], v14, s[20:23], s7 offen sc1
L_t3_34:
  s_waitcnt vmcnt(0)
  v_perm_b32 v18, v65, v64, s57
  v_perm_b32 v19, v67, v66, s58
  v_or_b32 v18, v18, v19
  v_xor_b32 v16, s52, v18
  v_cmp_ne_u32 s[40:41], 0, v16
  v_perm_b32 v18, v69, v68, s57
  v_perm_b32 v19, v71, v70, s58
  v_or_b32 v18, v18, v19
  v_xor_b32 v16, s52, v18
  v_cmp_ne_u32 s[42:43], 0, v16
  s_nop 0
  s_or_b64 s[44:45], s[40:41], s[42:43]
  s_cbranch_scc0 L_t3m_38
  s_add_u32 s48, s48, 1
  s_cmp_gt_u32 s48, 300000
  s_cbranch_scc1 L_t3m_38
  s_mov_b64 exec, s[40:41]
  s_cbranch_execz L_t3a_36
  buffer_load_dwordx4 v[64:67], v14, s[20:23], 0 offen sc1
L_t3a_36:
  s_mov_b64 exec, s[42:43]
  s_cbranch_execz L_t3b_37
  buffer_load_dwordx4 v[68:71], v14, s[20:23], s7 offen sc1
L_t3b_37:
  s_mov_b64 exec, -1
  s_branch L_t3_34
L_t3m_38:
  v_and_b32 v64, s63, v64
  v_and_b32 v65, s63, v65
  v_and_b32 v66, s63, v66
  v_and_b32 v67, s63, v67
  v_and_b32 v68, s63, v68
  v_and_b32 v69, s63, v69
  v_and_b32 v70, s63, v70
  v_and_b32 v71, s63, v71
  v_add_f32 v20, v64, v68
  v_add_f32 v21, v65, v69
  v_add_f32 v22, v66, v70
  v_add_f32 v23, v67, v71
L_t3d_35:
  v_permlane16_swap_b32 v20, v21
  s_nop 0
  v_permlane16_swap_b32 v22, v23
  v_add_f32 v20, v20, v21
  v_add_f32 v22, v22, v23
  s_nop 1
  v_permlane32_swap_b32 v20, v22
  v_add_f32 v20, v20, v22
  s_nop 1
  v_add_f32_dpp v20, v20, v20 row_ror:2 row_mask:0xf bank_mask:0xf
  s_nop 1
  v_add_f32_dpp v20, v20, v20 row_ror:4 row_mask:0xf bank_mask:0xf
  s_nop 1
  v_add_f32_dpp v20, v20, v20 row_ror:8 row_mask:0xf bank_mask:0xf
  v_cvt_pk_bf16_f32 v20, v20, v20
  s_mov_b32 exec_lo, 0x00030003
  s_mov_b32 exec_hi, 0x00030003
  buffer_store_short v20, v15, s[24:27], 0 offen
  s_mov_b64 exec, -1
  s_cmp_lg_u32 s2, 0
  s_cbranch_scc1 L_CW_noe
  s_cmp_lg_u32 s8, 0
  s_cbranch_scc1 L_CW_noe
  v_mov_b32 v5, 557056
  s_mov_b64 exec, 1
  buffer_store_dword v49, v5, s[20:23], 0 offen sc1
  s_mov_b64 exec, -1
L_CW_noe:
L_CW_end:
  s_endpgm
L_LD:
  s_sub_u32 s8, s3, 10
  v_mov_b32 v90, 161472
  v_mov_b32 v91, 1
  s_cmp_lg_u32 s8, 0
  s_cbranch_scc1 L_LD_noinit
  v_mov_b32 v8, 0
  v_mov_b32 v9, 0
  v_mov_b32 v10, 0
  v_mov_b32 v11, 0
  ds_write_b128 v90, v[8:11]
  ds_write_b128 v90, v[8:11] offset:16
  ds_write_b128 v90, v[8:11] offset:32
  s_waitcnt lgkmcnt(0)
L_LD_noinit:
  s_barrier
  s_load_dwordx2 s[16:17], s[0:1], 16
  s_mov_b32 s18, 33554432
  s_mov_b32 s19, 0x20000
  s_load_dwordx2 s[20:21], s[0:1], 32
  s_mov_b32 s22, 4194304
  s_mov_b32 s23, 0x20000
  s_load_dwordx2 s[24:25], s[0:1], 64
  s_mov_b32 s26, 1835008
  s_mov_b32 s27, 0x20000
  s_load_dwordx2 s[28:29], s[0:1], 96
  s_mov_b32 s30, 4194304
  s_mov_b32 s31, 0x20000
  v_and_b32 v1, 63, v0
  v_lshrrev_b32 v2, 4, v1
  v_and_b32 v3, 15, v1
  s_waitcnt lgkmcnt(0)
  s_and_b32 s6, s8, 1
  s_lshl_b32 s6, s6, 2
  v_add_u32 v5, s6, v2
  v_lshlrev_b32 v5, 1, v5
  v_xor_b32 v5, v5, v3
  v_lshlrev_b32 v5, 4, v5
  v_lshlrev_b32 v6, 8, v2
  v_add_u32 v10, v5, v6
  v_lshlrev_b32 v6, 17, v2
  v_add_u32 v11, v5, v6
  v_lshlrev_b32 v6, 10, v2
  v_add_u32 v16, v5, v6
  s_lshr_b32 s6, s5, 4
  s_lshl_b32 s6, s6, 3
  s_add_u32 s6, s6, s4
  s_lshl_b32 s10, s6, 21
  s_and_b32 s6, s5, 15
  s_lshl_b32 s6, s6, 17
  s_add_u32 s10, s10, s6
  s_and_b32 s6, s8, 1
  s_lshl_b32 s6, s6, 10
  s_add_u32 s10, s10, s6
  s_lshr_b32 s11, s5, 2
  s_and_b32 s12, s5, 3
  s_lshl_b32 s13, s4, 9
  s_lshl_b32 s6, s11, 4
  s_add_u32 s13, s13, s6
  s_add_u32 s13, s13, s8
  s_lshl_b32 s13, s13, 10
  s_lshl_b32 s6, s12, 8
  s_add_u32 s13, s13, s6
  s_lshl_b32 s14, s4, 3
  s_add_u32 s14, s14, s11
  s_mul_i32 s14, s14, 28
  s_lshl_b32 s6, s8, 2
  s_add_u32 s15, s14, s6
  s_add_u32 s6, s8, 4
  s_min_u32 s6, s6, 6
  s_lshl_b32 s6, s6, 2
  s_add_u32 s14, s14, s6
  s_lshl_b32 s15, s15, 10
  s_lshl_b32 s14, s14, 10
  s_lshl_b32 s6, s12, 8
  s_add_u32 s15, s15, s6
  s_add_u32 s14, s14, s6
  s_lshl_b32 s9, s8, 10
  s_cmp_lg_u32 s8, 2
  s_cbranch_scc1 L_tlb_39
  v_mov_b32 v20, 0
  s_mov_b64 exec, 1
  buffer_load_dword v21, v20, s[16:19], s10 offen
  buffer_load_dword v22, v20, s[20:23], s13 offen
  buffer_load_dword v23, v20, s[24:27], s15 offen
  s_mov_b32 s6, 1048576
  buffer_load_dword v24, v20, s[28:31], s6 offen
  s_mov_b32 s6, 1572864
  buffer_load_dword v25, v20, s[28:31], s6 offen
  s_mov_b32 s6, 524288
  buffer_load_dword v26, v20, s[28:31], s6 offen
  s_mov_b64 exec, -1
L_tlb_39:
L_lw_40:
  ds_read_b32 v7, v90 offset:8
  s_add_u32 s48, s48, 1
  s_waitcnt lgkmcnt(0)
  v_readfirstlane_b32 s49, v7
  s_nop 0
  s_cmp_ge_u32 s49, 4
  s_cbranch_scc1 L_lwd_41
  s_cmp_gt_u32 s48, 300000
  s_cbranch_scc1 L_lwd_41
  s_sleep 2
  s_branch L_lw_40
L_lwd_41:
L_lw_42:
  ds_read_b32 v7, v90 offset:32
  s_add_u32 s48, s48, 1
  s_waitcnt lgkmcnt(0)
  v_readfirstlane_b32 s49, v7
  s_nop 0
  s_cmp_ge_u32 s49, 2
  s_cbranch_scc1 L_lwd_43
  s_cmp_gt_u32 s48, 300000
  s_cbranch_scc1 L_lwd_43
  s_sleep 2
  s_branch L_lw_42
L_lwd_43:
  s_waitcnt vmcnt(0)
  s_mul_i32 s61, s5, 3
  s_mul_i32 s6, s4, 0
  s_add_u32 s61, s61, s6
  s_lshr_b32 s6, s8, 1
  s_add_u32 s61, s61, s6
  s_mul_i32 s62, s5, 1
  s_mul_i32 s6, s4, 0
  s_add_u32 s62, s62, s6
  s_add_u32 m0, s9, 0
  s_add_u32 s6, s61, 0
  s_and_b32 s6, s6, 7
  s_lshl_b32 s6, s6, 11
  s_add_u32 s6, s6, s10
  s_add_u32 s7, s62, 0
  s_and_b32 s7, s7, 7
  s_lshl_b32 s7, s7, 14
  s_add_u32 s6, s6, s7
  buffer_load_dwordx4 v10, s[16:19], s6 offen nt lds
  s_add_u32 m0, s9, 4096
  s_add_u32 s6, s61, 2
  s_and_b32 s6, s6, 7
  s_lshl_b32 s6, s6, 11
  s_add_u32 s6, s6, s10
  s_add_u32 s7, s62, 0
  s_and_b32 s7, s7, 7
  s_lshl_b32 s7, s7, 14
  s_add_u32 s6, s6, s7
  buffer_load_dwordx4 v10, s[16:19], s6 offen nt lds
  s_add_u32 m0, s9, 8192
  s_add_u32 s6, s61, 4
  s_and_b32 s6, s6, 7
  s_lshl_b32 s6, s6, 11
  s_add_u32 s6, s6, s10
  s_add_u32 s7, s62, 0
  s_and_b32 s7, s7, 7
  s_lshl_b32 s7, s7, 14
  s_add_u32 s6, s6, s7
  buffer_load_dwordx4 v10, s[16:19], s6 offen nt lds
  s_add_u32 m0, s9, 12288
  s_add_u32 s6, s61, 6
  s_and_b32 s6, s6, 7
  s_lshl_b32 s6, s6, 11
  s_add_u32 s6, s6, s10
  s_add_u32 s7, s62, 0
  s_and_b32 s7, s7, 7
  s_lshl_b32 s7, s7, 14
  s_add_u32 s6, s6, s7
  buffer_load_dwordx4 v10, s[16:19], s6 offen nt lds
  s_add_u32 m0, s9, 16384
  s_add_u32 s6, s61, 1
  s_and_b32 s6, s6, 7
  s_lshl_b32 s6, s6, 11
  s_add_u32 s6, s6, s10
  s_add_u32 s7, s62, 1
  s_and_b32 s7, s7, 7
  s_lshl_b32 s7, s7, 14
  s_add_u32 s6, s6, s7
  buffer_load_dwordx4 v10, s[16:19], s6 offen nt lds
  s_add_u32 m0, s9, 20480
  s_add_u32 s6, s61, 3
  s_and_b32 s6, s6, 7
  s_lshl_b32 s6, s6, 11
  s_add_u32 s6, s6, s10
  s_add_u32 s7, s62, 1
  s_and_b32 s7, s7, 7
  s_lshl_b32 s7, s7, 14
  s_add_u32 s6, s6, s7
  buffer_load_dwordx4 v10, s[16:19], s6 offen nt lds
  s_waitcnt vmcnt(5)
  s_add_u32 m0, s9, 24576
  s_add_u32 s6, s61, 5
  s_and_b32 s6, s6, 7
  s_lshl_b32 s6, s6, 11
  s_add_u32 s6, s6, s10
  s_add_u32 s7, s62, 1
  s_and_b32 s7, s7, 7
  s_lshl_b32 s7, s7, 14
  s_add_u32 s6, s6, s7
  buffer_load_dwordx4 v10, s[16:19], s6 offen nt lds
  s_waitcnt vmcnt(5)
  s_add_u32 m0, s9, 28672
  s_add_u32 s6, s61, 7
  s_and_b32 s6, s6, 7
  s_lshl_b32 s6, s6, 11
  s_add_u32 s6, s6, s10
  s_add_u32 s7, s62, 1
  s_and_b32 s7, s7, 7
  s_lshl_b32 s7, s7, 14
  s_add_u32 s6, s6, s7
  buffer_load_dwordx4 v10, s[16:19], s6 offen nt lds
  s_waitcnt vmcnt(5)
  s_add_u32 m0, s9, 32768
  s_add_u32 s6, s61, 2
  s_and_b32 s6, s6, 7
  s_lshl_b32 s6, s6, 11
  s_add_u32 s6, s6, s10
  s_add_u32 s7, s62, 2
  s_and_b32 s7, s7, 7
  s_lshl_b32 s7, s7, 14
  s_add_u32 s6, s6, s7
  buffer_load_dwordx4 v10, s[16:19], s6 offen nt lds
  s_waitcnt vmcnt(5)
  s_add_u32 m0, s9, 36864
  s_add_u32 s6, s61, 4
  s_and_b32 s6, s6, 7
  s_lshl_b32 s6, s6, 11
  s_add_u32 s6, s6, s10
  s_add_u32 s7, s62, 2
  s_and_b32 s7, s7, 7
  s_lshl_b32 s7, s7, 14
  s_add_u32 s6, s6, s7
  buffer_load_dwordx4 v10, s[16:19], s6 offen nt lds
  s_waitcnt vmcnt(5)
  s_add_u32 m0, s9, 40960
  s_add_u32 s6, s61, 6
  s_and_b32 s6, s6, 7
  s_lshl_b32 s6, s6, 11
  s_add_u32 s6, s6, s10
  s_add_u32 s7, s62, 2
  s_and_b32 s7, s7, 7
  s_lshl_b32 s7, s7, 14
  s_add_u32 s6, s6, s7
  buffer_load_dwordx4 v10, s[16:19], s6 offen nt lds
  s_waitcnt vmcnt(5)
  s_add_u32 m0, s9, 45056
  s_add_u32 s6, s61, 8
  s_and_b32 s6, s6, 7
  s_lshl_b32 s6, s6, 11
  s_add_u32 s6, s6, s10
  s_add_u32 s7, s62, 2
  s_and_b32 s7, s7, 7
  s_lshl_b32 s7, s7, 14
  s_add_u32 s6, s6, s7
  buffer_load_dwordx4 v10, s[16:19], s6 offen nt lds
  s_waitcnt vmcnt(5)
  s_add_u32 m0, s9, 49152
  s_add_u32 s6, s61, 3
  s_and_b32 s6, s6, 7
  s_lshl_b32 s6, s6, 11
  s_add_u32 s6, s6, s10
  s_add_u32 s7, s62, 3
  s_and_b32 s7, s7, 7
  s_lshl_b32 s7, s7, 14
  s_add_u32 s6, s6, s7
  buffer_load_dwordx4 v10, s[16:19], s6 offen nt lds
  s_waitcnt vmcnt(5)
  s_add_u32 m0, s9, 53248
  s_add_u32 s6, s61, 5
  s_and_b32 s6, s6, 7
  s_lshl_b32 s6, s6, 11
  s_add_u32 s6, s6, s10
  s_add_u32 s7, s62, 3
  s_and_b32 s7, s7, 7
  s_lshl_b32 s7, s7, 14
  s_add_u32 s6, s6, s7
  buffer_load_dwordx4 v10, s[16:19], s6 offen nt lds
  s_waitcnt vmcnt(5)
  s_add_u32 m0, s9, 57344
  s_add_u32 s6, s61, 7
  s_and_b32 s6, s6, 7
  s_lshl_b32 s6, s6, 11
  s_add_u32 s6, s6, s10
  s_add_u32 s7, s62, 3
  s_and_b32 s7, s7, 7
  s_lshl_b32 s7, s7, 14
  s_add_u32 s6, s6, s7
  buffer_load_dwordx4 v10, s[16:19], s6 offen nt lds
  s_waitcnt vmcnt(5)
  s_add_u32 m0, s9, 61440
  s_add_u32 s6, s61, 9
  s_and_b32 s6, s6, 7
  s_lshl_b32 s6, s6, 11
  s_add_u32 s6, s6, s10
  s_add_u32 s7, s62, 3
  s_and_b32 s7, s7, 7
  s_lshl_b32 s7, s7, 14
  s_add_u32 s6, s6, s7
  buffer_load_dwordx4 v10, s[16:19], s6 offen nt lds
  s_waitcnt vmcnt(5)
  s_add_u32 m0, s9, 65536
  s_add_u32 s6, s61, 4
  s_and_b32 s6, s6, 7
  s_lshl_b32 s6, s6, 11
  s_add_u32 s6, s6, s10
  s_add_u32 s7, s62, 4
  s_and_b32 s7, s7, 7
  s_lshl_b32 s7, s7, 14
  s_add_u32 s6, s6, s7
  buffer_load_dwordx4 v10, s[16:19], s6 offen nt lds
  s_waitcnt vmcnt(5)
  s_add_u32 m0, s9, 69632
  s_add_u32 s6, s61, 6
  s_and_b32 s6, s6, 7
  s_lshl_b32 s6, s6, 11
  s_add_u32 s6, s6, s10
  s_add_u32 s7, s62, 4
  s_and_b32 s7, s7, 7
  s_lshl_b32 s7, s7, 14
  s_add_u32 s6, s6, s7
  buffer_load_dwordx4 v10, s[16:19], s6 offen nt lds
  s_waitcnt vmcnt(5)
  s_add_u32 m0, s9, 73728
  s_add_u32 s6, s61, 8
  s_and_b32 s6, s6, 7
  s_lshl_b32 s6, s6, 11
  s_add_u32 s6, s6, s10
  s_add_u32 s7, s62, 4
  s_and_b32 s7, s7, 7
  s_lshl_b32 s7, s7, 14
  s_add_u32 s6, s6, s7
  buffer_load_dwordx4 v10, s[16:19], s6 offen nt lds
  s_waitcnt vmcnt(5)
  s_add_u32 m0, s9, 77824
  s_add_u32 s6, s61, 10
  s_and_b32 s6, s6, 7
  s_lshl_b32 s6, s6, 11
  s_add_u32 s6, s6, s10
  s_add_u32 s7, s62, 4
  s_and_b32 s7, s7, 7
  s_lshl_b32 s7, s7, 14
  s_add_u32 s6, s6, s7
  buffer_load_dwordx4 v10, s[16:19], s6 offen nt lds
  s_waitcnt vmcnt(5)
  s_add_u32 m0, s9, 81920
  s_add_u32 s6, s61, 5
  s_and_b32 s6, s6, 7
  s_lshl_b32 s6, s6, 11
  s_add_u32 s6, s6, s10
  s_add_u32 s7, s62, 5
  s_and_b32 s7, s7, 7
  s_lshl_b32 s7, s7, 14
  s_add_u32 s6, s6, s7
  buffer_load_dwordx4 v10, s[16:19], s6 offen nt lds
  s_waitcnt vmcnt(5)
  s_add_u32 m0, s9, 86016
  s_add_u32 s6, s61, 7
  s_and_b32 s6, s6, 7
  s_lshl_b32 s6, s6, 11
  s_add_u32 s6, s6, s10
  s_add_u32 s7, s62, 5
  s_and_b32 s7, s7, 7
  s_lshl_b32 s7, s7, 14
  s_add_u32 s6, s6, s7
  buffer_load_dwordx4 v10, s[16:19], s6 offen nt lds
  s_waitcnt vmcnt(5)
  s_add_u32 m0, s9, 90112
  s_add_u32 s6, s61, 9
  s_and_b32 s6, s6, 7
  s_lshl_b32 s6, s6, 11
  s_add_u32 s6, s6, s10
  s_add_u32 s7, s62, 5
  s_and_b32 s7, s7, 7
  s_lshl_b32 s7, s7, 14
  s_add_u32 s6, s6, s7
  buffer_load_dwordx4 v10, s[16:19], s6 offen nt lds
  s_waitcnt vmcnt(5)
  s_add_u32 m0, s9, 94208
  s_add_u32 s6, s61, 11
  s_and_b32 s6, s6, 7
  s_lshl_b32 s6, s6, 11
  s_add_u32 s6, s6, s10
  s_add_u32 s7, s62, 5
  s_and_b32 s7, s7, 7
  s_lshl_b32 s7, s7, 14
  s_add_u32 s6, s6, s7
  buffer_load_dwordx4 v10, s[16:19], s6 offen nt lds
  s_waitcnt vmcnt(5)
  s_add_u32 m0, s9, 98304
  s_add_u32 s6, s61, 6
  s_and_b32 s6, s6, 7
  s_lshl_b32 s6, s6, 11
  s_add_u32 s6, s6, s10
  s_add_u32 s7, s62, 6
  s_and_b32 s7, s7, 7
  s_lshl_b32 s7, s7, 14
  s_add_u32 s6, s6, s7
  buffer_load_dwordx4 v10, s[16:19], s6 offen nt lds
  s_waitcnt vmcnt(5)
  s_add_u32 m0, s9, 102400
  s_add_u32 s6, s61, 8
  s_and_b32 s6, s6, 7
  s_lshl_b32 s6, s6, 11
  s_add_u32 s6, s6, s10
  s_add_u32 s7, s62, 6
  s_and_b32 s7, s7, 7
  s_lshl_b32 s7, s7, 14
  s_add_u32 s6, s6, s7
  buffer_load_dwordx4 v10, s[16:19], s6 offen nt lds
  s_waitcnt vmcnt(5)
  s_add_u32 m0, s9, 106496
  s_add_u32 s6, s61, 10
  s_and_b32 s6, s6, 7
  s_lshl_b32 s6, s6, 11
  s_add_u32 s6, s6, s10
  s_add_u32 s7, s62, 6
  s_and_b32 s7, s7, 7
  s_lshl_b32 s7, s7, 14
  s_add_u32 s6, s6, s7
  buffer_load_dwordx4 v10, s[16:19], s6 offen nt lds
  s_waitcnt vmcnt(5)
  s_add_u32 m0, s9, 110592
  s_add_u32 s6, s61, 12
  s_and_b32 s6, s6, 7
  s_lshl_b32 s6, s6, 11
  s_add_u32 s6, s6, s10
  s_add_u32 s7, s62, 6
  s_and_b32 s7, s7, 7
  s_lshl_b32 s7, s7, 14
  s_add_u32 s6, s6, s7
  buffer_load_dwordx4 v10, s[16:19], s6 offen nt lds
  s_waitcnt vmcnt(5)
  s_add_u32 m0, s9, 114688
  s_add_u32 s6, s61, 7
  s_and_b32 s6, s6, 7
  s_lshl_b32 s6, s6, 11
  s_add_u32 s6, s6, s10
  s_add_u32 s7, s62, 7
  s_and_b32 s7, s7, 7
  s_lshl_b32 s7, s7, 14
  s_add_u32 s6, s6, s7
  buffer_load_dwordx4 v10, s[16:19], s6 offen nt lds
  s_waitcnt vmcnt(5)
  s_add_u32 m0, s9, 118784
  s_add_u32 s6, s61, 9
  s_and_b32 s6, s6, 7
  s_lshl_b32 s6, s6, 11
  s_add_u32 s6, s6, s10
  s_add_u32 s7, s62, 7
  s_and_b32 s7, s7, 7
  s_lshl_b32 s7, s7, 14
  s_add_u32 s6, s6, s7
  buffer_load_dwordx4 v10, s[16:19], s6 offen nt lds
  s_waitcnt vmcnt(5)
  s_add_u32 m0, s9, 122880
  s_add_u32 s6, s61, 11
  s_and_b32 s6, s6, 7
  s_lshl_b32 s6, s6, 11
  s_add_u32 s6, s6, s10
  s_add_u32 s7, s62, 7
  s_and_b32 s7, s7, 7
  s_lshl_b32 s7, s7, 14
  s_add_u32 s6, s6, s7
  buffer_load_dwordx4 v10, s[16:19], s6 offen nt lds
  s_waitcnt vmcnt(5)
  s_add_u32 m0, s9, 126976
  s_add_u32 s6, s61, 13
  s_and_b32 s6, s6, 7
  s_lshl_b32 s6, s6, 11
  s_add_u32 s6, s6, s10
  s_add_u32 s7, s62, 7
  s_and_b32 s7, s7, 7
  s_lshl_b32 s7, s7, 14
  s_add_u32 s6, s6, s7
  buffer_load_dwordx4 v10, s[16:19], s6 offen nt lds
  s_waitcnt vmcnt(5)
  s_add_u32 m0, s9, 131072
  s_add_u32 s6, s13, 0
  buffer_load_dwordx4 v11, s[20:23], s6 offen nt lds
  s_waitcnt vmcnt(5)
  s_add_u32 m0, s9, 135168
  s_add_u32 s6, s13, 4096
  buffer_load_dwordx4 v11, s[20:23], s6 offen nt lds
  s_mov_b64 exec, 1
  ds_add_u32 v90, v91 offset:20
  s_mov_b64 exec, -1
  s_waitcnt vmcnt(5)
  s_add_u32 m0, s9, 139264
  s_add_u32 s6, s13, 8192
  buffer_load_dwordx4 v11, s[20:23], s6 offen nt lds
  s_waitcnt vmcnt(5)
  s_add_u32 m0, s9, 143360
  s_add_u32 s6, s13, 12288
  buffer_load_dwordx4 v11, s[20:23], s6 offen nt lds
  s_waitcnt vmcnt(5)
  s_add_u32 m0, s9, 147456
  s_nop 0
  buffer_load_dwordx4 v16, s[24:27], s15 offen nt lds
  s_waitcnt vmcnt(5)
  s_add_u32 m0, s9, 151552
  s_nop 0
  buffer_load_dwordx4 v16, s[24:27], s14 offen nt lds
  s_barrier
  s_waitcnt vmcnt(0)
  s_barrier
  s_endpgm
L_exit:
  s_endpgm
L_codeend:
.section .rodata,"a"
.p2align 6
.amdhsa_kernel gated_mix__gqa_block_cached__swiglu_ffn__decode_kernel
  .amdhsa_next_free_vgpr 128
  .amdhsa_next_free_sgpr 102
  .amdhsa_accum_offset 128
  .amdhsa_group_segment_fixed_size 0
  .amdhsa_kernarg_size 104
  .amdhsa_user_sgpr_count 2
  .amdhsa_user_sgpr_kernarg_segment_ptr 1
  .amdhsa_system_sgpr_workgroup_id_x 1
.end_amdhsa_kernel
```
